```python
import torch

def _softmax(x, axis=-1):
    return torch.softmax(x, dim=axis)
def _gelu(x):
    return torch.nn.functional.gelu(x, approximate="tanh")
def _silu(x):
    return torch.nn.functional.silu(x)
def _sigmoid(x):
    return torch.sigmoid(x)
def _layernorm(x, axis=-1, eps=1e-5):
    m = x.mean(dim=axis, keepdim=True)
    v = x.var(dim=axis, keepdim=True, unbiased=False)
    return (x - m) / torch.sqrt(v + eps)
def _scatter_add(tgt, idx, src, axis=0):
    return tgt.clone().index_add_(axis, idx, src)
def _segment_sum(src, seg, n):
    out = torch.zeros((n,) + src.shape[1:], dtype=src.dtype)
    return out.index_add_(0, seg, src)
def _pad(x, pw):
    flat = tuple(v for pair in reversed(pw) for v in pair)
    return torch.nn.functional.pad(x, flat)

kernel_name = 'gated_mix__linear_attn_block__grouped_kv_mqa__prompt'

def setup_inputs():

    _w = (lambda a: (lambda t: t.to(torch.bfloat16) if t.is_floating_point() else t)(torch.as_tensor(a)))
    def _A_setup():
        B, S, D = 1, 2048, 512
        return {
            "x": _w((lambda *s: torch.randn(*s, dtype=torch.bfloat16) * 0.05)(B, S, D)),
            "wqkv": _w((lambda *s: torch.randn(*s, dtype=torch.bfloat16) * 1.6)(D, 3 * D)),
            "wo": _w((lambda *s: torch.randn(*s, dtype=torch.bfloat16) * 0.05)(D, D)),
        }
    _A_in = _A_setup()

    def _B_setup():
        B, S, D, H = 1, 2048, 512, 32
        Dh = D // H
        return {
            "x": _w((lambda *s: torch.randn(*s, dtype=torch.bfloat16) * 0.05)(B, S, D)),
            "wq": _w((lambda *s: torch.randn(*s, dtype=torch.bfloat16) * 1.6)(D, H * Dh)),
            "wk": _w((lambda *s: torch.randn(*s, dtype=torch.bfloat16) * 1.6)(D, Dh)),
            "wv": _w((lambda *s: torch.randn(*s, dtype=torch.bfloat16) * 0.05)(D, Dh)),
            "wo": _w((lambda *s: torch.randn(*s, dtype=torch.bfloat16) * 0.05)(H * Dh, D)),
        }
    _B_in = _B_setup()

    return {
        "A_x": _A_in["x"],
        "A_wqkv": _A_in["wqkv"],
        "A_wo": _A_in["wo"],
        "B_x": _B_in["x"],
        "B_wq": _B_in["wq"],
        "B_wk": _B_in["wk"],
        "B_wv": _B_in["wv"],
        "B_wo": _B_in["wo"],
        "gate_w": _w((lambda *s: torch.randn(*s, dtype=torch.bfloat16) * 0.05)(512) * 16.0),
    }

def reference(A_x, A_wqkv, A_wo, B_x, B_wq, B_wk, B_wv, B_wo, gate_w):
    def _A_ref(x, wqkv, wo):
        B, S, D = x.shape
        H = 32; Dh = D // H
        qkv = (lambda x, *d: x.permute(*d))((x @ wqkv).reshape(B, S, 3, H, Dh), 2, 0, 3, 1, 4)
        q, k, v = qkv[0], qkv[1], qkv[2]
        phi = lambda t: torch.where(t > 0, t + 1, torch.exp(t)) + 1e-6
        pq, pk = phi(q), phi(k)
        kv = torch.einsum("bhsd,bhse->bhde", pk, v)
        z = torch.einsum("bhsd->bhd", pk)
        num = torch.einsum("bhqd,bhde->bhqe", pq, kv)
        den = torch.einsum("bhqd,bhd->bhq", pq, z)[..., None] + 1e-6
        o = num / den
        return (lambda x, *d: x.permute(*d))(o, 0, 2, 1, 3).reshape(B, S, D) @ wo

    def _B_ref(x, wq, wk, wv, wo):
        B, S, D = x.shape
        H = 32
        Dh = D // H
        q = (lambda x, *d: x.permute(*d))((x @ wq).reshape(B, S, H, Dh), 0, 2, 1, 3)
        k = x @ wk
        v = x @ wv
        scores = torch.einsum("bhqd,bkd->bhqk", q, k) * (Dh ** -0.5)
        p = _softmax(scores, axis=-1)
        o = torch.einsum("bhqk,bkd->bhqd", p, v)
        return (lambda x, *d: x.permute(*d))(o, 0, 2, 1, 3).reshape(B, S, H * Dh) @ wo

    x = A_x
    g = _sigmoid((x * gate_w).sum(-1, keepdims=True))
    a = _A_ref(x, A_wqkv, A_wo)
    b = _B_ref(x, B_wq, B_wk, B_wv, B_wo)
    return g * a + (1 - g) * b
```

```asm
; @launch grid=(256,1,1) block=(768,1,1) lds=163840
.amdgcn_target "amdgcn-amd-amdhsa--gfx950"
.text
.globl gated_mix__linear_attn_block__grouped_kv_mqa__prompt_kernel
.p2align 8
.type gated_mix__linear_attn_block__grouped_kv_mqa__prompt_kernel,@function
gated_mix__linear_attn_block__grouped_kv_mqa__prompt_kernel:
    s_cmp_ge_u32 s2, 256
    s_cbranch_scc1 END
    s_load_dwordx16 s[4:19], s[0:1], 0
    s_load_dwordx8 s[20:27], s[0:1], 64
    v_lshrrev_b32 v21, 6, v0
    v_and_b32 v1, 63, v0
    v_readfirstlane_b32 s44, v21
    s_bfe_u32 s3, s2, 0x30003
    s_lshr_b32 s61, s2, 6
    s_and_b32 s46, s2, 6
    s_lshl_b32 s46, s46, 2
    s_add_u32 s46, s46, s3
    s_and_b32 s47, s2, 1
    s_lshl_b32 s47, s47, 2
    s_add_u32 s47, s47, s61
    s_add_u32 s49, s3, s61
    s_lshl_b32 s49, s49, 1
    s_lshr_b32 s60, s3, 2
    s_add_u32 s49, s49, s60
    s_and_b32 s49, s49, 7
    s_mov_b32 s67, 0
    s_mov_b32 s30, 0x1000000
    s_mov_b32 s31, 0x20000
    s_and_b32 s45, s44, 3
    s_cmp_lt_u32 s44, 8
    s_cbranch_scc1 NOTLD
    s_setprio 2
    v_lshrrev_b32 v20, 3, v1
    v_and_b32 v21, 7, v1
    v_lshrrev_b32 v22, 4, v1
    s_lshl_b32 s3, s45, 4
    v_add_u32 v20, s3, v20
    v_xor_b32 v23, v21, v22
    v_lshlrev_b32 v23, 4, v23
    v_lshl_add_u32 v23, v20, 10, v23
    s_lshl_b32 s3, s46, 16
    v_add_u32 v12, s3, v23
    v_xor_b32 v13, 64, v12
    v_add_u32 v13, 0x2000, v13
    v_and_b32 v22, 1, v22
    v_lshlrev_b32 v22, 2, v22
    v_xor_b32 v21, v21, v22
    v_lshlrev_b32 v21, 4, v21
    s_lshl_b32 s3, s47, 7
    v_add_u32 v21, s3, v21
    v_lshl_add_u32 v16, v20, 10, v21
    v_xor_b32 v16, 256, v16
    v_add_u32 v17, 0x2000, v16
    s_lshl_b32 s55, s45, 11
    s_mov_b32 s34, 0x200000
    s_mov_b32 s35, 0x20000
    s_mov_b32 s42, 0x80000
    s_mov_b32 s43, 0x20000
    s_mov_b32 s62, s49
    s_waitcnt lgkmcnt(0)
    s_mov_b64 s[32:33], s[4:5]
    s_mov_b64 s[40:41], s[12:13]
    s_mov_b32 s63, s49
    s_lshl_b32 s51, s63, 7
    s_add_u32 m0, s55, 0x10000
    s_nop 0
    buffer_load_dwordx4 v12, s[32:35], s51 offen lds
    s_add_u32 m0, s55, 0x10400
    s_nop 0
    buffer_load_dwordx4 v13, s[32:35], s51 offen lds
    s_add_u32 s63, s63, 1
    s_and_b32 s63, s63, 7
    s_lshl_b32 s53, s49, 16
    s_add_u32 m0, s55, 0x0
    s_nop 0
    buffer_load_dwordx4 v16, s[40:43], s53 offen lds
    s_add_u32 m0, s55, 0x400
    s_nop 0
    buffer_load_dwordx4 v17, s[40:43], s53 offen lds
    s_add_u32 s49, s49, 1
    s_and_b32 s49, s49, 7
    s_lshl_b32 s51, s63, 7
    s_add_u32 m0, s55, 0x12000
    s_nop 0
    buffer_load_dwordx4 v12, s[32:35], s51 offen lds
    s_add_u32 m0, s55, 0x12400
    s_nop 0
    buffer_load_dwordx4 v13, s[32:35], s51 offen lds
    s_add_u32 s63, s63, 1
    s_and_b32 s63, s63, 7
    s_lshl_b32 s53, s49, 16
    s_add_u32 m0, s55, 0x2000
    s_nop 0
    buffer_load_dwordx4 v16, s[40:43], s53 offen lds
    s_add_u32 m0, s55, 0x2400
    s_nop 0
    buffer_load_dwordx4 v17, s[40:43], s53 offen lds
    s_add_u32 s49, s49, 1
    s_and_b32 s49, s49, 7
    s_setprio 0
    s_movk_i32 s60, 3072
    v_mad_u32_u24 v18, v20, s60, v21
    v_add_u32 v19, 24576, v18
    v_xor_b32 v21, 128, v21
    v_mad_u32_u24 v22, v20, s60, v21
    v_add_u32 v23, 24576, v22
    s_mov_b64 s[36:37], s[6:7]
    s_mov_b32 s38, 0x180000
    s_mov_b32 s39, 0x20000
    s_mov_b64 s[28:29], s[26:27]
    s_and_b32 s3, s2, 7
    s_lshl_b32 s3, s3, 5
    s_lshr_b32 s46, s2, 3
    s_add_u32 s46, s46, s3
    s_lshr_b32 s47, s46, 2
    s_and_b32 s48, s46, 3
    s_lshl_b32 s52, s47, 15
    s_lshl_b32 s10, s48, 7
    s_add_u32 s52, s52, s10
    s_sub_u32 s45, s44, 4
    v_lshlrev_b32 v3, 2, v1
    v_bfe_u32 v112, v1, 3, 2
    v_lshlrev_b32 v112, 10, v112
    v_and_b32 v113, 0x27, v1
    v_lshl_add_u32 v112, v113, 4, v112
    v_lshlrev_b32 v0, 4, v1
    v_lshrrev_b32 v114, 5, v1
    v_and_b32 v115, 15, v1
    v_lshl_add_u32 v114, v114, 4, v115
    v_lshlrev_b32 v114, 4, v114
    v_bfe_u32 v115, v1, 4, 1
    v_lshl_add_u32 v114, v115, 9, v114
    s_lshr_b32 s15, s2, 3
    s_and_b32 s15, s15, 7
    s_xor_b32 s15, s15, s45
    s_lshl_b32 s11, s15, 13
    s_add_u32 s12, s11, 0x410000
    s_add_u32 s11, s11, 0x400000
    s_add_u32 s13, s11, 4096
    s_add_u32 s14, s12, 4096
    s_lshl_b32 s18, s15, 12
    s_add_u32 s18, s18, 0x4b0000
    v_lshl_add_u32 v118, v1, 8, s18
    s_lshr_b32 s19, s46, 3
    s_lshl_b32 s19, s19, 10
    s_add_u32 s19, s19, 0x4b0000
    v_and_b32 v115, 7, v1
    v_lshl_add_u32 v115, v115, 7, s19
    v_cmp_lt_u32 vcc, 15, v1
    s_nop 1
    v_cndmask_b32 v118, v118, v115, vcc
    s_lshl_b32 s19, s45, 13
    s_add_u32 s19, s19, 0x4a6080
    v_lshl_add_u32 v115, v1, 8, s19
    v_cmp_lt_u32 vcc, 31, v1
    s_nop 1
    v_cndmask_b32 v118, v118, v115, vcc
    v_and_b32 v116, 11, v1
    v_cmp_eq_u32 vcc, 0, v116
    v_mov_b32 v117, 0x3f803f80
    s_nop 0
    v_cndmask_b32 v116, 0, v117, vcc
    v_mov_b32 v117, v116
    v_pk_mov_b32 v[44:45], v[116:117], v[116:117]
    v_pk_mov_b32 v[46:47], v[116:117], v[116:117]
    v_pk_mov_b32 v[52:53], v[116:117], v[116:117]
    v_pk_mov_b32 v[54:55], v[116:117], v[116:117]
    v_pk_mov_b32 v[60:61], v[116:117], v[116:117]
    v_pk_mov_b32 v[62:63], v[116:117], v[116:117]
    v_pk_mov_b32 v[68:69], v[116:117], v[116:117]
    v_pk_mov_b32 v[70:71], v[116:117], v[116:117]
    v_pk_mov_b32 v[76:77], v[116:117], v[116:117]
    v_pk_mov_b32 v[78:79], v[116:117], v[116:117]
    v_pk_mov_b32 v[84:85], v[116:117], v[116:117]
    v_pk_mov_b32 v[86:87], v[116:117], v[116:117]
    v_pk_mov_b32 v[92:93], v[116:117], v[116:117]
    v_pk_mov_b32 v[94:95], v[116:117], v[116:117]
    v_pk_mov_b32 v[100:101], v[116:117], v[116:117]
    v_pk_mov_b32 v[102:103], v[116:117], v[116:117]
    v_mov_b32 v136, 0
    v_mov_b32 v137, 0
    v_mov_b32 v138, 0
    v_mov_b32 v139, 0
    v_mov_b32 v140, 0
    v_mov_b32 v141, 0
    v_mov_b32 v142, 0
    v_mov_b32 v143, 0
    v_mov_b32 v144, 0
    v_mov_b32 v152, 0
    v_mov_b32 v153, 0
    v_mov_b32 v154, 0
    v_mov_b32 v155, 0
    v_mov_b32 v156, 0
    v_mov_b32 v157, 0
    v_mov_b32 v158, 0
    v_mov_b32 v159, 0
    v_mov_b32 v160, 0
    v_mov_b32 v2, 0xdddd
    s_lshl_b32 s3, s45, 11
    s_add_u32 s3, s3, 65536
    v_add_u32 v1, s3, v0
    s_lshl_b32 m0, s45, 8
    s_mul_i32 s54, s62, 0x30000
    s_add_u32 m0, s55, 0x6000
    s_nop 0
    buffer_load_dwordx4 v22, s[36:39], s54 offen lds
    s_add_u32 m0, s55, 0x6400
    s_nop 0
    buffer_load_dwordx4 v23, s[36:39], s54 offen lds
    s_add_u32 s54, s54, 1024
    s_add_u32 m0, s55, 0x8000
    s_nop 0
    buffer_load_dwordx4 v18, s[36:39], s54 offen lds
    s_add_u32 m0, s55, 0x8400
    s_nop 0
    buffer_load_dwordx4 v19, s[36:39], s54 offen lds
    s_add_u32 s54, s54, 1024
    s_add_u32 m0, s55, 0xa000
    s_nop 0
    buffer_load_dwordx4 v18, s[36:39], s54 offen lds
    s_add_u32 m0, s55, 0xa400
    s_nop 0
    buffer_load_dwordx4 v19, s[36:39], s54 offen lds
    s_add_u32 s62, s62, 1
    s_and_b32 s62, s62, 7
    s_waitcnt vmcnt(6)
    s_barrier
    s_lshl_b32 s51, s63, 7
    s_add_u32 m0, s55, 0x14000
    s_nop 0
    buffer_load_dwordx4 v12, s[32:35], s51 offen lds
    s_add_u32 m0, s55, 0x14400
    s_nop 0
    buffer_load_dwordx4 v13, s[32:35], s51 offen lds
    s_add_u32 s63, s63, 1
    s_and_b32 s63, s63, 7
    s_lshl_b32 s53, s49, 16
    s_add_u32 m0, s55, 0x20000
    s_nop 0
    buffer_load_dwordx4 v16, s[40:43], s53 offen lds
    s_add_u32 m0, s55, 0x20400
    s_nop 0
    buffer_load_dwordx4 v17, s[40:43], s53 offen lds
    s_add_u32 s49, s49, 1
    s_and_b32 s49, s49, 7
    s_lshl_b32 s51, s63, 7
    s_add_u32 m0, s55, 0x16000
    s_nop 0
    buffer_load_dwordx4 v12, s[32:35], s51 offen lds
    s_add_u32 m0, s55, 0x16400
    s_nop 0
    buffer_load_dwordx4 v13, s[32:35], s51 offen lds
    s_add_u32 s63, s63, 1
    s_and_b32 s63, s63, 7
    s_lshl_b32 s53, s49, 16
    s_add_u32 m0, s55, 0x22000
    s_nop 0
    buffer_load_dwordx4 v16, s[40:43], s53 offen lds
    s_add_u32 m0, s55, 0x22400
    s_nop 0
    buffer_load_dwordx4 v17, s[40:43], s53 offen lds
    s_add_u32 s49, s49, 1
    s_and_b32 s49, s49, 7
    s_waitcnt vmcnt(8)
    s_barrier
    s_lshl_b32 s51, s63, 7
    s_add_u32 m0, s55, 0x18000
    s_nop 0
    buffer_load_dwordx4 v12, s[32:35], s51 offen lds
    s_add_u32 m0, s55, 0x18400
    s_nop 0
    buffer_load_dwordx4 v13, s[32:35], s51 offen lds
    s_add_u32 s63, s63, 1
    s_and_b32 s63, s63, 7
    s_lshl_b32 s53, s49, 16
    s_add_u32 m0, s55, 0x0
    s_nop 0
    buffer_load_dwordx4 v16, s[40:43], s53 offen lds
    s_add_u32 m0, s55, 0x400
    s_nop 0
    buffer_load_dwordx4 v17, s[40:43], s53 offen lds
    s_add_u32 s49, s49, 1
    s_and_b32 s49, s49, 7
    s_lshl_b32 s51, s63, 7
    s_add_u32 m0, s55, 0x1a000
    s_nop 0
    buffer_load_dwordx4 v12, s[32:35], s51 offen lds
    s_add_u32 m0, s55, 0x1a400
    s_nop 0
    buffer_load_dwordx4 v13, s[32:35], s51 offen lds
    s_add_u32 s63, s63, 1
    s_and_b32 s63, s63, 7
    s_lshl_b32 s53, s49, 16
    s_add_u32 m0, s55, 0x2000
    s_nop 0
    buffer_load_dwordx4 v16, s[40:43], s53 offen lds
    s_add_u32 m0, s55, 0x2400
    s_nop 0
    buffer_load_dwordx4 v17, s[40:43], s53 offen lds
    s_add_u32 s49, s49, 1
    s_and_b32 s49, s49, 7
    s_waitcnt vmcnt(8)
    s_barrier
    s_lshl_b32 s51, s63, 7
    s_add_u32 m0, s55, 0x1c000
    s_nop 0
    buffer_load_dwordx4 v12, s[32:35], s51 offen lds
    s_add_u32 m0, s55, 0x1c400
    s_nop 0
    buffer_load_dwordx4 v13, s[32:35], s51 offen lds
    s_add_u32 s63, s63, 1
    s_and_b32 s63, s63, 7
    s_lshl_b32 s53, s49, 16
    s_add_u32 m0, s55, 0x6000
    s_nop 0
    buffer_load_dwordx4 v16, s[40:43], s53 offen lds
    s_add_u32 m0, s55, 0x6400
    s_nop 0
    buffer_load_dwordx4 v17, s[40:43], s53 offen lds
    s_add_u32 s49, s49, 1
    s_and_b32 s49, s49, 7
    s_lshl_b32 s51, s63, 7
    s_add_u32 m0, s55, 0x1e000
    s_nop 0
    buffer_load_dwordx4 v12, s[32:35], s51 offen lds
    s_add_u32 m0, s55, 0x1e400
    s_nop 0
    buffer_load_dwordx4 v13, s[32:35], s51 offen lds
    s_add_u32 s63, s63, 1
    s_and_b32 s63, s63, 7
    s_lshl_b32 s53, s49, 16
    s_add_u32 m0, s55, 0x8000
    s_nop 0
    buffer_load_dwordx4 v16, s[40:43], s53 offen lds
    s_add_u32 m0, s55, 0x8400
    s_nop 0
    buffer_load_dwordx4 v17, s[40:43], s53 offen lds
    s_add_u32 s49, s49, 1
    s_and_b32 s49, s49, 7
    s_waitcnt vmcnt(8)
    s_barrier
    s_mul_i32 s54, s62, 0x30000
    s_add_u32 m0, s55, 0x20000
    s_nop 0
    buffer_load_dwordx4 v22, s[36:39], s54 offen lds
    s_add_u32 m0, s55, 0x20400
    s_nop 0
    buffer_load_dwordx4 v23, s[36:39], s54 offen lds
    s_add_u32 s54, s54, 1024
    s_add_u32 m0, s55, 0x22000
    s_nop 0
    buffer_load_dwordx4 v18, s[36:39], s54 offen lds
    s_add_u32 m0, s55, 0x22400
    s_nop 0
    buffer_load_dwordx4 v19, s[36:39], s54 offen lds
    s_add_u32 s54, s54, 1024
    s_add_u32 m0, s55, 0x24000
    s_nop 0
    buffer_load_dwordx4 v18, s[36:39], s54 offen lds
    s_add_u32 m0, s55, 0x24400
    s_nop 0
    buffer_load_dwordx4 v19, s[36:39], s54 offen lds
    s_add_u32 s62, s62, 1
    s_and_b32 s62, s62, 7
    s_waitcnt vmcnt(6)
    s_barrier
    s_mul_i32 s54, s62, 0x30000
    s_add_u32 m0, s55, 0x0
    s_nop 0
    buffer_load_dwordx4 v22, s[36:39], s54 offen lds
    s_add_u32 m0, s55, 0x400
    s_nop 0
    buffer_load_dwordx4 v23, s[36:39], s54 offen lds
    s_add_u32 s54, s54, 1024
    s_add_u32 m0, s55, 0x2000
    s_nop 0
    buffer_load_dwordx4 v18, s[36:39], s54 offen lds
    s_add_u32 m0, s55, 0x2400
    s_nop 0
    buffer_load_dwordx4 v19, s[36:39], s54 offen lds
    s_add_u32 s54, s54, 1024
    s_add_u32 m0, s55, 0x4000
    s_nop 0
    buffer_load_dwordx4 v18, s[36:39], s54 offen lds
    s_add_u32 m0, s55, 0x4400
    s_nop 0
    buffer_load_dwordx4 v19, s[36:39], s54 offen lds
    s_add_u32 s62, s62, 1
    s_and_b32 s62, s62, 7
    s_waitcnt vmcnt(6)
    s_barrier
    s_mul_i32 s54, s62, 0x30000
    s_add_u32 m0, s55, 0x6000
    s_nop 0
    buffer_load_dwordx4 v22, s[36:39], s54 offen lds
    s_add_u32 m0, s55, 0x6400
    s_nop 0
    buffer_load_dwordx4 v23, s[36:39], s54 offen lds
    s_add_u32 s54, s54, 1024
    s_add_u32 m0, s55, 0x8000
    s_nop 0
    buffer_load_dwordx4 v18, s[36:39], s54 offen lds
    s_add_u32 m0, s55, 0x8400
    s_nop 0
    buffer_load_dwordx4 v19, s[36:39], s54 offen lds
    s_add_u32 s54, s54, 1024
    s_add_u32 m0, s55, 0xa000
    s_nop 0
    buffer_load_dwordx4 v18, s[36:39], s54 offen lds
    s_add_u32 m0, s55, 0xa400
    s_nop 0
    buffer_load_dwordx4 v19, s[36:39], s54 offen lds
    s_add_u32 s62, s62, 1
    s_and_b32 s62, s62, 7
    s_waitcnt vmcnt(6)
    s_barrier
    s_mul_i32 s54, s62, 0x30000
    s_add_u32 m0, s55, 0x20000
    s_nop 0
    buffer_load_dwordx4 v22, s[36:39], s54 offen lds
    s_add_u32 m0, s55, 0x20400
    s_nop 0
    buffer_load_dwordx4 v23, s[36:39], s54 offen lds
    s_add_u32 s54, s54, 1024
    s_add_u32 m0, s55, 0x22000
    s_nop 0
    buffer_load_dwordx4 v18, s[36:39], s54 offen lds
    s_add_u32 m0, s55, 0x22400
    s_nop 0
    buffer_load_dwordx4 v19, s[36:39], s54 offen lds
    s_add_u32 s54, s54, 1024
    s_add_u32 m0, s55, 0x24000
    s_nop 0
    buffer_load_dwordx4 v18, s[36:39], s54 offen lds
    s_add_u32 m0, s55, 0x24400
    s_nop 0
    buffer_load_dwordx4 v19, s[36:39], s54 offen lds
    s_add_u32 s62, s62, 1
    s_and_b32 s62, s62, 7
    s_waitcnt vmcnt(6)
    s_barrier
    s_mul_i32 s54, s62, 0x30000
    s_add_u32 m0, s55, 0x0
    s_nop 0
    buffer_load_dwordx4 v22, s[36:39], s54 offen lds
    s_add_u32 m0, s55, 0x400
    s_nop 0
    buffer_load_dwordx4 v23, s[36:39], s54 offen lds
    s_add_u32 s54, s54, 1024
    s_add_u32 m0, s55, 0x2000
    s_nop 0
    buffer_load_dwordx4 v18, s[36:39], s54 offen lds
    s_add_u32 m0, s55, 0x2400
    s_nop 0
    buffer_load_dwordx4 v19, s[36:39], s54 offen lds
    s_add_u32 s54, s54, 1024
    s_add_u32 m0, s55, 0x4000
    s_nop 0
    buffer_load_dwordx4 v18, s[36:39], s54 offen lds
    s_add_u32 m0, s55, 0x4400
    s_nop 0
    buffer_load_dwordx4 v19, s[36:39], s54 offen lds
    s_add_u32 s62, s62, 1
    s_and_b32 s62, s62, 7
    s_waitcnt vmcnt(6)
    s_barrier
    s_mul_i32 s54, s62, 0x30000
    s_add_u32 m0, s55, 0x6000
    s_nop 0
    buffer_load_dwordx4 v22, s[36:39], s54 offen lds
    s_add_u32 m0, s55, 0x6400
    s_nop 0
    buffer_load_dwordx4 v23, s[36:39], s54 offen lds
    s_add_u32 s54, s54, 1024
    s_add_u32 m0, s55, 0x8000
    s_nop 0
    buffer_load_dwordx4 v18, s[36:39], s54 offen lds
    s_add_u32 m0, s55, 0x8400
    s_nop 0
    buffer_load_dwordx4 v19, s[36:39], s54 offen lds
    s_add_u32 s54, s54, 1024
    s_add_u32 m0, s55, 0xa000
    s_nop 0
    buffer_load_dwordx4 v18, s[36:39], s54 offen lds
    s_add_u32 m0, s55, 0xa400
    s_nop 0
    buffer_load_dwordx4 v19, s[36:39], s54 offen lds
    s_add_u32 s62, s62, 1
    s_and_b32 s62, s62, 7
    s_waitcnt vmcnt(6)
    s_barrier
    s_mul_i32 s54, s62, 0x30000
    s_add_u32 m0, s55, 0x20000
    s_nop 0
    buffer_load_dwordx4 v22, s[36:39], s54 offen lds
    s_add_u32 m0, s55, 0x20400
    s_nop 0
    buffer_load_dwordx4 v23, s[36:39], s54 offen lds
    s_add_u32 s54, s54, 1024
    s_add_u32 m0, s55, 0x22000
    s_nop 0
    buffer_load_dwordx4 v18, s[36:39], s54 offen lds
    s_add_u32 m0, s55, 0x22400
    s_nop 0
    buffer_load_dwordx4 v19, s[36:39], s54 offen lds
    s_add_u32 s54, s54, 1024
    s_add_u32 m0, s55, 0x24000
    s_nop 0
    buffer_load_dwordx4 v18, s[36:39], s54 offen lds
    s_add_u32 m0, s55, 0x24400
    s_nop 0
    buffer_load_dwordx4 v19, s[36:39], s54 offen lds
    s_add_u32 s62, s62, 1
    s_and_b32 s62, s62, 7
    s_waitcnt vmcnt(6)
    s_barrier
    v_mov_b32 v27, 0
    s_mov_b32 s3, 0x47c000
    buffer_load_dword v26, v27, s[28:31], s3 offen sc1
    s_waitcnt vmcnt(0)
    s_barrier
    buffer_load_dword v120, v118, s[28:31], 0 offen sc1
    v_add_u32 v26, 0x9e3779b1, v26
    s_setprio 3
    v_readfirstlane_b32 s57, v26
    s_lshl_b32 m0, s45, 8
    s_waitcnt vmcnt(0)
    v_cmp_ne_u32 vcc, v26, v120
    s_cbranch_vccz YMF_G
YMF:
    buffer_load_dword v120, v118, s[28:31], 0 offen sc1
    s_waitcnt vmcnt(0)
    v_cmp_ne_u32 vcc, s57, v120
    s_cbranch_vccz YMF_G
    s_mov_b64 exec, vcc
    s_add_u32 s67, s67, 1
    s_cmp_gt_u32 s67, 0x100000
    s_cbranch_scc1 END
    s_sleep 4
    s_branch YMF
YMF_G:
    s_mov_b64 exec, -1
    buffer_load_dwordx4 v[4:7], v112, s[28:31], s52 offen sc1
    buffer_load_dwordx4 v[8:11], v0, s[28:31], s11 offen offset:0 sc1
    buffer_load_dwordx4 v[40:43], v114, s[28:31], s12 offen offset:0 sc1
    buffer_load_dwordx4 v[12:15], v0, s[28:31], s11 offen offset:1024 sc1
    buffer_load_dwordx4 v[48:51], v114, s[28:31], s12 offen offset:1024 sc1
    buffer_load_dwordx4 v[16:19], v0, s[28:31], s11 offen offset:2048 sc1
    buffer_load_dwordx4 v[56:59], v114, s[28:31], s12 offen offset:2048 sc1
    buffer_load_dwordx4 v[20:23], v0, s[28:31], s11 offen offset:3072 sc1
    buffer_load_dwordx4 v[64:67], v114, s[28:31], s12 offen offset:3072 sc1
    buffer_load_dwordx4 v[24:27], v0, s[28:31], s13 offen offset:0 sc1
    buffer_load_dwordx4 v[72:75], v114, s[28:31], s14 offen offset:0 sc1
    buffer_load_dwordx4 v[28:31], v0, s[28:31], s13 offen offset:1024 sc1
    buffer_load_dwordx4 v[80:83], v114, s[28:31], s14 offen offset:1024 sc1
    buffer_load_dwordx4 v[32:35], v0, s[28:31], s13 offen offset:2048 sc1
    buffer_load_dwordx4 v[88:91], v114, s[28:31], s14 offen offset:2048 sc1
    buffer_load_dwordx4 v[36:39], v0, s[28:31], s13 offen offset:3072 sc1
    buffer_load_dwordx4 v[96:99], v114, s[28:31], s14 offen offset:3072 sc1
    ds_add_u32 v3, v2 offset:62720
    s_branch GO
NOTLD:
    s_cmp_lt_u32 s44, 4
    s_cbranch_scc1 GEMM
    s_setprio 1
    v_lshlrev_b32 v120, 4, v1
    v_bfe_u32 v121, v1, 2, 2
    v_and_b32 v122, 3, v1
    v_lshrrev_b32 v123, 4, v1
    v_and_b32 v124, 15, v1
    v_mov_b32 v127, 0
    s_mov_b32 s39, 0x20000
    s_mov_b32 s3, 0x47c000
    s_lshr_b32 s48, s47, 1
    s_waitcnt lgkmcnt(0)
    s_mov_b64 s[28:29], s[26:27]
    buffer_load_dword v128, v127, s[28:31], s3 offen sc1
    s_bitcmp1_b32 s47, 0
    s_cbranch_scc1 LAY
    s_cmp_lt_u32 s48, 2
    s_cselect_b64 s[36:37], s[14:15], s[16:17]
    s_mov_b32 s38, 0x4000
    s_lshl_b32 s3, s45, 12
    s_cmp_lt_u32 s45, 2
    s_mov_b32 s63, 0x24000
    s_cselect_b32 s63, 0xc000, s63
    s_add_u32 m0, s3, s63
    s_lshr_b32 s63, s48, 1
    buffer_load_dwordx4 v120, s[36:39], s3 offen offset:0 lds
    buffer_load_dwordx4 v120, s[36:39], s3 offen offset:1024 lds
    buffer_load_dwordx4 v120, s[36:39], s3 offen offset:2048 lds
    buffer_load_dwordx4 v120, s[36:39], s3 offen offset:3072 lds
    s_mov_b64 s[36:37], s[20:21]
    s_mov_b32 s38, 0x400
    s_mov_b32 s39, 0x20000
    s_mov_b32 m0, 0xe000
    s_and_b32 s51, s48, 1
    buffer_load_dwordx4 v120, s[36:39], 0 offen lds
    s_lshl_b32 s51, s51, 1
    s_add_u32 s51, s51, s45
    s_cmp_lt_u32 s45, 2
    s_cselect_b32 s50, s63, s45
    s_cselect_b32 s51, s51, s48
    v_bfe_u32 v108, v1, 1, 3
    v_xor_b32 v108, v108, v123
    v_lshlrev_b32 v108, 4, v108
    v_lshl_add_u32 v108, v124, 7, v108
    s_lshl_b32 s3, s51, 11
    s_add_u32 s3, s3, 0x10000
    v_add_u32 v108, s3, v108
    v_xor_b32 v109, 64, v108
    v_lshl_add_u32 v129, v123, 3, v121
    v_lshlrev_b32 v129, 5, v129
    v_lshl_add_u32 v129, v122, 3, v129
    v_lshlrev_b32 v130, 4, v123
    v_mov_b32 v104, 0
    v_mov_b32 v105, 0
    v_mov_b32 v106, 0
    v_mov_b32 v107, 0
    s_lshl_b32 s3, s46, 2
    s_add_u32 s62, s51, s3
    s_lshr_b32 s3, s62, 1
    s_lshl_b32 s3, s3, 10
    s_and_b32 s63, s62, 1
    s_add_u32 s66, s50, 8
    s_lshl_b32 s63, s63, s66
    s_add_u32 s3, s3, s63
    s_lshl_b32 s63, s50, 16
    s_add_u32 s3, s3, s63
    s_add_u32 s64, s3, 0x400000
    s_lshl_b32 s3, s62, 6
    s_add_u32 s65, s3, 0x420000
    v_and_b32 v110, 1, v123
    v_lshrrev_b32 v111, 1, v123
    v_lshl_add_u32 v125, v110, 5, v124
    v_lshlrev_b32 v125, 4, v125
    v_lshl_add_u32 v125, v111, 3, v125
    v_lshl_add_u32 v126, v111, 4, v124
    v_lshlrev_b32 v126, 4, v126
    v_lshl_add_u32 v126, v110, 3, v126
    s_cmp_eq_u32 s50, 1
    s_cselect_b64 vcc, -1, 0
    s_cselect_b32 s63, 1.0, 0x3eb8aa3b
    v_cndmask_b32 v125, v125, v126, vcc
    s_branch ASET
LAY:
    s_mov_b32 s50, 4
    s_lshl_b32 s62, s46, 2
    s_add_u32 s62, s62, s48
    s_cmp_lt_u32 s62, 64
    s_cselect_b64 s[36:37], s[18:19], s[8:9]
    s_mov_b32 s38, 0x80000
    s_bfe_u32 s63, s62, 0x40002
    s_and_b32 s53, s62, 3
    s_lshl_b32 s3, s63, 15
    s_lshl_b32 s65, s53, 8
    s_add_u32 s3, s3, s65
    s_lshl_b32 s65, s45, 13
    s_add_u32 s3, s3, s65
    v_lshlrev_b32 v108, 4, v124
    v_lshl_add_u32 v108, v123, 10, v108
    s_lshl_b32 s65, s45, 11
    s_add_u32 m0, s65, 49152
    s_add_u32 s65, s3, 4096
    buffer_load_dwordx4 v108, s[36:39], s3 offen lds
    s_add_u32 m0, m0, 1024
    v_lshlrev_b32 v109, 2, v1
    buffer_load_dwordx4 v108, s[36:39], s65 offen lds
    s_cmp_eq_u32 s45, 1
    s_cbranch_scc0 NOMK
    s_lshl_b32 s65, s62, 8
    s_add_u32 s65, s65, 0x430000
    v_mov_b32 v110, -1
    buffer_store_dword v110, v109, s[28:31], s65 offen sc1
NOMK:
    s_lshl_b32 s3, s45, 2
    v_lshl_add_u32 v129, v124, 4, s3
    v_lshl_add_u32 v125, v123, 11, v129
    s_lshr_b32 s3, s63, 1
    s_lshl_b32 s3, s3, 2
    s_add_u32 s3, s3, s53
    s_lshl_b32 s3, s3, 14
    s_and_b32 s65, s63, 1
    s_lshl_b32 s65, s65, 10
    s_add_u32 s3, s3, s65
    s_lshl_b32 s65, s45, 12
    s_add_u32 s3, s3, s65
    s_add_u32 s64, s3, 0x500000
    v_and_b32 v135, 18, v1
    v_bfe_u32 v126, v1, 2, 1
    v_lshl_add_u32 v135, v126, 3, v135
    v_bfe_u32 v126, v1, 3, 1
    v_lshl_add_u32 v135, v126, 2, v135
    s_lshl_b32 s3, s45, 6
    v_lshl_add_u32 v135, v135, 1, s3
    v_lshrrev_b32 v126, 5, v1
    v_lshl_add_u32 v135, v126, 10, v135
    v_and_b32 v126, 1, v1
    v_mul_u32_u24 v126, 0x020202, v126
    v_lshl_or_b32 v126, v126, 8, v126
    v_add_u32 v126, 0x05040100, v126
    s_lshl_b32 s3, s53, 17
    s_lshl_b32 s65, s63, 11
    s_add_u32 s3, s3, s65
    s_lshl_b32 s65, s45, 15
    s_add_u32 s3, s3, s65
    s_mov_b32 s66, 0x580000
    s_cmp_lt_u32 s62, 64
    s_cselect_b32 s66, 0x780000, s66
    s_cselect_b32 s50, 4, 5
    s_add_u32 s65, s3, s66
    s_cmp_lt_u32 s62, 32
    s_cselect_b32 s50, 5, s50
ASET:
    s_and_b32 s3, s2, 7
    s_lshl_b32 s3, s3, 5
    s_lshr_b32 s46, s2, 3
    s_add_u32 s46, s46, s3
    s_lshr_b32 s47, s46, 2
    s_and_b32 s48, s46, 3
    s_lshl_b32 s52, s47, 15
    s_lshl_b32 s10, s48, 7
    s_add_u32 s52, s52, s10
    s_sub_u32 s45, s44, 4
    v_lshlrev_b32 v3, 2, v1
    v_bfe_u32 v112, v1, 3, 2
    v_lshlrev_b32 v112, 10, v112
    v_and_b32 v113, 0x27, v1
    v_lshl_add_u32 v112, v113, 4, v112
    v_lshlrev_b32 v0, 4, v1
    v_lshrrev_b32 v114, 5, v1
    v_and_b32 v115, 15, v1
    v_lshl_add_u32 v114, v114, 4, v115
    v_lshlrev_b32 v114, 4, v114
    v_bfe_u32 v115, v1, 4, 1
    v_lshl_add_u32 v114, v115, 9, v114
    s_lshr_b32 s15, s2, 3
    s_and_b32 s15, s15, 7
    s_xor_b32 s15, s15, s45
    s_lshl_b32 s11, s15, 13
    s_add_u32 s12, s11, 0x410000
    s_add_u32 s11, s11, 0x400000
    s_add_u32 s13, s11, 4096
    s_add_u32 s14, s12, 4096
    s_lshl_b32 s18, s15, 12
    s_add_u32 s18, s18, 0x4b0000
    v_lshl_add_u32 v118, v1, 8, s18
    s_lshr_b32 s19, s46, 3
    s_lshl_b32 s19, s19, 10
    s_add_u32 s19, s19, 0x4b0000
    v_and_b32 v115, 7, v1
    v_lshl_add_u32 v115, v115, 7, s19
    v_cmp_lt_u32 vcc, 15, v1
    s_nop 1
    v_cndmask_b32 v118, v118, v115, vcc
    v_and_b32 v116, 11, v1
    v_cmp_eq_u32 vcc, 0, v116
    v_mov_b32 v117, 0x3f803f80
    s_nop 0
    v_cndmask_b32 v116, 0, v117, vcc
    v_mov_b32 v117, v116
    v_pk_mov_b32 v[44:45], v[116:117], v[116:117]
    v_pk_mov_b32 v[46:47], v[116:117], v[116:117]
    v_pk_mov_b32 v[52:53], v[116:117], v[116:117]
    v_pk_mov_b32 v[54:55], v[116:117], v[116:117]
    v_pk_mov_b32 v[60:61], v[116:117], v[116:117]
    v_pk_mov_b32 v[62:63], v[116:117], v[116:117]
    v_pk_mov_b32 v[68:69], v[116:117], v[116:117]
    v_pk_mov_b32 v[70:71], v[116:117], v[116:117]
    v_pk_mov_b32 v[76:77], v[116:117], v[116:117]
    v_pk_mov_b32 v[78:79], v[116:117], v[116:117]
    v_pk_mov_b32 v[84:85], v[116:117], v[116:117]
    v_pk_mov_b32 v[86:87], v[116:117], v[116:117]
    v_pk_mov_b32 v[92:93], v[116:117], v[116:117]
    v_pk_mov_b32 v[94:95], v[116:117], v[116:117]
    v_pk_mov_b32 v[100:101], v[116:117], v[116:117]
    v_pk_mov_b32 v[102:103], v[116:117], v[116:117]
    v_mov_b32 v136, 0
    v_mov_b32 v137, 0
    v_mov_b32 v138, 0
    v_mov_b32 v139, 0
    v_mov_b32 v140, 0
    v_mov_b32 v141, 0
    v_mov_b32 v142, 0
    v_mov_b32 v143, 0
    v_mov_b32 v144, 0
    v_mov_b32 v152, 0
    v_mov_b32 v153, 0
    v_mov_b32 v154, 0
    v_mov_b32 v155, 0
    v_mov_b32 v156, 0
    v_mov_b32 v157, 0
    v_mov_b32 v158, 0
    v_mov_b32 v159, 0
    v_mov_b32 v160, 0
    v_mov_b32 v2, 0xdddd
    s_lshl_b32 s3, s45, 11
    s_add_u32 s3, s3, 65536
    v_add_u32 v1, s3, v0
    s_lshl_b32 m0, s45, 8
    s_mov_b32 s56, 0
    s_waitcnt vmcnt(0)
    v_add_u32 v128, 0x9e3779b1, v128
    s_nop 0
    v_readfirstlane_b32 s57, v128
AUXL:
    s_lshl_b32 s3, s49, 11
    s_add_u32 s62, s3, 0xc000
    s_add_u32 s3, s3, 0x24000
    s_cmp_lt_u32 s49, 4
    s_cselect_b32 s3, s62, s3
    v_add_u32 v131, s3, v129
    s_lshl_b32 s3, s49, 7
    v_add_u32 v133, s3, v130
    s_add_u32 s49, s49, 1
    s_and_b32 s49, s49, 7
    s_lshl_b32 s3, s49, 11
    s_add_u32 s62, s3, 0xc000
    s_add_u32 s3, s3, 0x24000
    s_cmp_lt_u32 s49, 4
    s_cselect_b32 s3, s62, s3
    v_add_u32 v132, s3, v129
    s_lshl_b32 s3, s49, 7
    v_add_u32 v134, s3, v130
    s_add_u32 s49, s49, 1
    s_and_b32 s49, s49, 7
    s_add_u32 s56, s56, 1
    s_barrier
    s_sub_u32 s3, s56, 2
    s_cmp_lt_u32 s3, 1
    s_cbranch_scc0 AUXE
    s_barrier
AUXE:
    s_cmp_ge_u32 s50, 3
    s_cbranch_scc1 AUXC
    ds_read_b128 v[8:11], v108 offset:0
    ds_read_b128 v[12:15], v109 offset:0
    ds_read_b128 v[16:19], v108 offset:8192
    ds_read_b128 v[20:23], v109 offset:8192
    s_cmp_eq_u32 s50, 2
    s_cbranch_scc1 AUXR
    ds_read_b64_tr_b16 v[24:25], v131 offset:0
    ds_read_b64_tr_b16 v[26:27], v131 offset:128
    ds_read_b64_tr_b16 v[28:29], v131 offset:1024
    ds_read_b64_tr_b16 v[30:31], v131 offset:1152
    ds_read_b64_tr_b16 v[32:33], v132 offset:0
    ds_read_b64_tr_b16 v[34:35], v132 offset:128
    ds_read_b64_tr_b16 v[36:37], v132 offset:1024
    ds_read_b64_tr_b16 v[38:39], v132 offset:1152
    s_branch AUXM
AUXR:
    ds_read_b128 v[24:27], v133 offset:57344
    ds_read_b128 v[28:31], v133 offset:57408
    ds_read_b128 v[32:35], v134 offset:57344
    ds_read_b128 v[36:39], v134 offset:57408
AUXM:
    v_add_u32 v108, 0x4000, v108
    v_add_u32 v109, 0x4000, v109
    s_waitcnt lgkmcnt(0)
    s_cmp_eq_u32 s50, 1
    s_cbranch_scc1 AUXB
    v_mfma_f32_16x16x32_bf16 v[104:107], v[24:27], v[8:11], v[104:107]
    v_mfma_f32_16x16x32_bf16 v[104:107], v[28:31], v[12:15], v[104:107]
    v_mfma_f32_16x16x32_bf16 v[104:107], v[32:35], v[16:19], v[104:107]
    v_mfma_f32_16x16x32_bf16 v[104:107], v[36:39], v[20:23], v[104:107]
    s_branch AUXC
AUXB:
    v_mfma_f32_16x16x32_bf16 v[104:107], v[8:11], v[24:27], v[104:107]
    v_mfma_f32_16x16x32_bf16 v[104:107], v[12:15], v[28:31], v[104:107]
    v_mfma_f32_16x16x32_bf16 v[104:107], v[16:19], v[32:35], v[104:107]
    v_mfma_f32_16x16x32_bf16 v[104:107], v[20:23], v[36:39], v[104:107]
AUXC:
    s_cmp_lt_u32 s56, 4
    s_cbranch_scc1 AUXL
    s_nop 5
    s_cmp_lt_u32 s50, 2
    s_cbranch_scc1 AUXK
    s_cmp_eq_u32 s50, 3
    s_cbranch_scc1 AUXD
    s_cmp_eq_u32 s50, 4
    s_cbranch_scc1 AUXT
    s_cmp_ge_u32 s50, 5
    s_cbranch_scc1 AUXU
    v_mul_f32 v104, 0xbfb8aa3b, v104
    v_exp_f32 v104, v104
    s_nop 0
    v_add_f32 v104, 1.0, v104
    v_rcp_f32 v104, v104
    s_mov_b64 exec, 0xffff
    buffer_store_dword v104, v3, s[28:31], s65 offen sc1
    s_mov_b64 exec, -1
    s_branch AUXD
AUXK:
    v_mul_f32 v104, s63, v104
    v_mul_f32 v105, s63, v105
    v_mul_f32 v106, s63, v106
    v_mul_f32 v107, s63, v107
    v_cvt_pk_bf16_f32 v110, v104, v105
    v_cvt_pk_bf16_f32 v111, v106, v107
    buffer_store_dwordx2 v[110:111], v125, s[28:31], s64 offen sc1
    s_branch AUXD
AUXU:
    ds_read_b32 v8, v135 offset:49152
    ds_read_b32 v9, v135 offset:49408
    ds_read_b32 v10, v135 offset:49664
    ds_read_b32 v11, v135 offset:49920
    ds_read_b32 v12, v135 offset:51200
    ds_read_b32 v13, v135 offset:51456
    ds_read_b32 v14, v135 offset:51712
    ds_read_b32 v15, v135 offset:51968
    ds_read_b32 v16, v135 offset:53248
    ds_read_b32 v17, v135 offset:53504
    ds_read_b32 v18, v135 offset:53760
    ds_read_b32 v19, v135 offset:54016
    ds_read_b32 v20, v135 offset:55296
    ds_read_b32 v21, v135 offset:55552
    s_waitcnt lgkmcnt(8)
    ds_read_b32 v22, v135 offset:55808
    ds_read_b32 v23, v135 offset:56064
    s_waitcnt lgkmcnt(0)
    v_perm_b32 v24, v9, v8, v126
    v_perm_b32 v25, v11, v10, v126
    v_perm_b32 v26, v13, v12, v126
    v_perm_b32 v27, v15, v14, v126
    v_perm_b32 v28, v17, v16, v126
    v_perm_b32 v29, v19, v18, v126
    v_perm_b32 v30, v21, v20, v126
    v_perm_b32 v31, v23, v22, v126
    buffer_store_dwordx4 v[24:27], v0, s[28:31], s65 offen sc1
    buffer_store_dwordx4 v[28:31], v0, s[28:31], s65 offen offset:1024 sc1
    s_branch AUXD
AUXT:
    ds_read_b32 v8, v125 offset:49152
    ds_read_b32 v9, v125 offset:49408
    ds_read_b32 v10, v125 offset:50176
    ds_read_b32 v11, v125 offset:50432
    ds_read_b32 v12, v125 offset:49664
    ds_read_b32 v13, v125 offset:49920
    ds_read_b32 v14, v125 offset:50688
    ds_read_b32 v15, v125 offset:50944
    s_mov_b32 s3, 0x05040100
    s_mov_b32 s62, 0x07060302
    s_waitcnt lgkmcnt(0)
    v_perm_b32 v104, v9, v8, s3
    v_perm_b32 v105, v11, v10, s3
    v_perm_b32 v106, v13, v12, s3
    v_perm_b32 v107, v15, v14, s3
    v_perm_b32 v108, v9, v8, s62
    v_perm_b32 v109, v11, v10, s62
    v_perm_b32 v110, v13, v12, s62
    v_perm_b32 v111, v15, v14, s62
    buffer_store_dwordx4 v[104:107], v0, s[28:31], s64 offen sc1
    buffer_store_dwordx4 v[108:111], v0, s[28:31], s64 offen offset:2048 sc1
AUXD:
    s_barrier
    s_barrier
    s_waitcnt vmcnt(0)
    s_barrier
    s_barrier
    s_barrier
    s_barrier
    s_setprio 3
    buffer_load_dword v120, v118, s[28:31], 0 offen sc1
    s_waitcnt vmcnt(0)
    v_cmp_ne_u32 vcc, s57, v120
    s_cbranch_vccnz OLATE
    buffer_load_dwordx4 v[4:7], v112, s[28:31], s52 offen sc1
    buffer_load_dwordx4 v[8:11], v0, s[28:31], s11 offen offset:0 sc1
    buffer_load_dwordx4 v[40:43], v114, s[28:31], s12 offen offset:0 sc1
    buffer_load_dwordx4 v[12:15], v0, s[28:31], s11 offen offset:1024 sc1
    buffer_load_dwordx4 v[48:51], v114, s[28:31], s12 offen offset:1024 sc1
    buffer_load_dwordx4 v[16:19], v0, s[28:31], s11 offen offset:2048 sc1
    buffer_load_dwordx4 v[56:59], v114, s[28:31], s12 offen offset:2048 sc1
    s_barrier
    s_branch OREST
OLATE:
    s_barrier
    s_mov_b64 exec, vcc
OMF:
    buffer_load_dword v120, v118, s[28:31], 0 offen sc1
    s_waitcnt vmcnt(0)
    v_cmp_ne_u32 vcc, s57, v120
    s_cbranch_vccz OMF_G
    s_mov_b64 exec, vcc
    s_add_u32 s67, s67, 1
    s_cmp_gt_u32 s67, 0x100000
    s_cbranch_scc1 END
    s_sleep 4
    s_branch OMF
OMF_G:
    s_mov_b64 exec, -1
    buffer_load_dwordx4 v[4:7], v112, s[28:31], s52 offen sc1
    buffer_load_dwordx4 v[8:11], v0, s[28:31], s11 offen offset:0 sc1
    buffer_load_dwordx4 v[40:43], v114, s[28:31], s12 offen offset:0 sc1
    buffer_load_dwordx4 v[12:15], v0, s[28:31], s11 offen offset:1024 sc1
    buffer_load_dwordx4 v[48:51], v114, s[28:31], s12 offen offset:1024 sc1
    buffer_load_dwordx4 v[16:19], v0, s[28:31], s11 offen offset:2048 sc1
    buffer_load_dwordx4 v[56:59], v114, s[28:31], s12 offen offset:2048 sc1
OREST:
    buffer_load_dwordx4 v[20:23], v0, s[28:31], s11 offen offset:3072 sc1
    buffer_load_dwordx4 v[64:67], v114, s[28:31], s12 offen offset:3072 sc1
    buffer_load_dwordx4 v[24:27], v0, s[28:31], s13 offen offset:0 sc1
    buffer_load_dwordx4 v[72:75], v114, s[28:31], s14 offen offset:0 sc1
    buffer_load_dwordx4 v[28:31], v0, s[28:31], s13 offen offset:1024 sc1
    buffer_load_dwordx4 v[80:83], v114, s[28:31], s14 offen offset:1024 sc1
    buffer_load_dwordx4 v[32:35], v0, s[28:31], s13 offen offset:2048 sc1
    buffer_load_dwordx4 v[88:91], v114, s[28:31], s14 offen offset:2048 sc1
    buffer_load_dwordx4 v[36:39], v0, s[28:31], s13 offen offset:3072 sc1
    buffer_load_dwordx4 v[96:99], v114, s[28:31], s14 offen offset:3072 sc1
    ds_add_u32 v3, v2 offset:62720
    s_lshl_b32 s3, s45, 13
    s_add_u32 s3, s3, s52
    s_lshl_b32 s10, s45, 11
    s_add_u32 m0, s10, 12288
    s_add_u32 s11, s3, 4096
    buffer_load_dwordx4 v112, s[28:31], s3 offen sc1 lds
    s_add_u32 m0, m0, 1024
    s_nop 0
    buffer_load_dwordx4 v112, s[28:31], s11 offen sc1 lds
    s_lshl_b32 m0, s45, 8
GO:
    s_waitcnt vmcnt(15)
    v_mfma_f32_32x32x16_bf16 v[104:119], v[8:11], v[4:7], 0
    s_nop 11
    v_exp_f32 v104, v104
    v_exp_f32 v105, v105
    v_exp_f32 v106, v106
    v_exp_f32 v107, v107
    v_exp_f32 v108, v108
    s_waitcnt vmcnt(13)
    v_mfma_f32_32x32x16_bf16 v[120:135], v[12:15], v[4:7], 0
    v_permlane16_swap_b32 v40, v44
    v_exp_f32 v109, v109
    v_permlane16_swap_b32 v41, v45
    v_exp_f32 v110, v110
    v_permlane16_swap_b32 v42, v46
    v_exp_f32 v111, v111
    v_permlane16_swap_b32 v43, v47
    v_exp_f32 v112, v112
    v_exp_f32 v113, v113
    v_exp_f32 v114, v114
    v_smfmac_f32_32x32x32_bf16 v[136:151], v[40:43], v[104:111], v2
    v_exp_f32 v115, v115
    v_exp_f32 v116, v116
    v_exp_f32 v117, v117
    v_exp_f32 v118, v118
    v_exp_f32 v119, v119
    v_exp_f32 v120, v120
    v_exp_f32 v121, v121
    v_smfmac_f32_32x32x32_bf16 v[136:151], v[44:47], v[112:119], v2
    v_exp_f32 v122, v122
    v_exp_f32 v123, v123
    v_exp_f32 v124, v124
    s_waitcnt vmcnt(11)
    v_mfma_f32_32x32x16_bf16 v[104:119], v[16:19], v[4:7], 0
    v_permlane16_swap_b32 v48, v52
    v_exp_f32 v125, v125
    v_permlane16_swap_b32 v49, v53
    v_exp_f32 v126, v126
    v_permlane16_swap_b32 v50, v54
    v_exp_f32 v127, v127
    v_permlane16_swap_b32 v51, v55
    v_exp_f32 v128, v128
    v_exp_f32 v129, v129
    v_exp_f32 v130, v130
    v_smfmac_f32_32x32x32_bf16 v[136:151], v[48:51], v[120:127], v2
    v_exp_f32 v131, v131
    v_exp_f32 v132, v132
    v_exp_f32 v133, v133
    v_exp_f32 v134, v134
    v_exp_f32 v135, v135
    v_exp_f32 v104, v104
    v_exp_f32 v105, v105
    v_smfmac_f32_32x32x32_bf16 v[136:151], v[52:55], v[128:135], v2
    v_exp_f32 v106, v106
    v_exp_f32 v107, v107
    v_exp_f32 v108, v108
    s_waitcnt vmcnt(9)
    v_mfma_f32_32x32x16_bf16 v[120:135], v[20:23], v[4:7], 0
    v_permlane16_swap_b32 v56, v60
    v_exp_f32 v109, v109
    v_permlane16_swap_b32 v57, v61
    v_exp_f32 v110, v110
    v_permlane16_swap_b32 v58, v62
    v_exp_f32 v111, v111
    v_permlane16_swap_b32 v59, v63
    v_exp_f32 v112, v112
    v_exp_f32 v113, v113
    v_exp_f32 v114, v114
    v_smfmac_f32_32x32x32_bf16 v[136:151], v[56:59], v[104:111], v2
    v_exp_f32 v115, v115
    v_exp_f32 v116, v116
    v_exp_f32 v117, v117
    v_exp_f32 v118, v118
    v_exp_f32 v119, v119
    v_exp_f32 v120, v120
    v_exp_f32 v121, v121
    v_smfmac_f32_32x32x32_bf16 v[136:151], v[60:63], v[112:119], v2
    v_exp_f32 v122, v122
    v_exp_f32 v123, v123
    v_exp_f32 v124, v124
    s_waitcnt vmcnt(7)
    v_mfma_f32_32x32x16_bf16 v[104:119], v[24:27], v[4:7], 0
    v_permlane16_swap_b32 v64, v68
    v_exp_f32 v125, v125
    v_permlane16_swap_b32 v65, v69
    v_exp_f32 v126, v126
    v_permlane16_swap_b32 v66, v70
    v_exp_f32 v127, v127
    v_permlane16_swap_b32 v67, v71
    v_exp_f32 v128, v128
    v_exp_f32 v129, v129
    v_exp_f32 v130, v130
    v_smfmac_f32_32x32x32_bf16 v[136:151], v[64:67], v[120:127], v2
    v_exp_f32 v131, v131
    v_exp_f32 v132, v132
    v_exp_f32 v133, v133
    v_exp_f32 v134, v134
    v_exp_f32 v135, v135
    v_exp_f32 v104, v104
    v_exp_f32 v105, v105
    v_smfmac_f32_32x32x32_bf16 v[136:151], v[68:71], v[128:135], v2
    v_exp_f32 v106, v106
    v_exp_f32 v107, v107
    v_exp_f32 v108, v108
    s_waitcnt vmcnt(5)
    v_mfma_f32_32x32x16_bf16 v[120:135], v[28:31], v[4:7], 0
    v_permlane16_swap_b32 v72, v76
    v_exp_f32 v109, v109
    v_permlane16_swap_b32 v73, v77
    v_exp_f32 v110, v110
    v_permlane16_swap_b32 v74, v78
    v_exp_f32 v111, v111
    v_permlane16_swap_b32 v75, v79
    v_exp_f32 v112, v112
    v_exp_f32 v113, v113
    v_exp_f32 v114, v114
    v_smfmac_f32_32x32x32_bf16 v[136:151], v[72:75], v[104:111], v2
    v_exp_f32 v115, v115
    v_exp_f32 v116, v116
    v_exp_f32 v117, v117
    v_exp_f32 v118, v118
    v_exp_f32 v119, v119
    v_exp_f32 v120, v120
    v_exp_f32 v121, v121
    v_smfmac_f32_32x32x32_bf16 v[136:151], v[76:79], v[112:119], v2
    v_exp_f32 v122, v122
    v_exp_f32 v123, v123
    v_exp_f32 v124, v124
    s_waitcnt vmcnt(3)
    v_mfma_f32_32x32x16_bf16 v[104:119], v[32:35], v[4:7], 0
    v_permlane16_swap_b32 v80, v84
    v_exp_f32 v125, v125
    v_permlane16_swap_b32 v81, v85
    v_exp_f32 v126, v126
    v_permlane16_swap_b32 v82, v86
    v_exp_f32 v127, v127
    v_permlane16_swap_b32 v83, v87
    v_exp_f32 v128, v128
    v_exp_f32 v129, v129
    v_exp_f32 v130, v130
    v_smfmac_f32_32x32x32_bf16 v[136:151], v[80:83], v[120:127], v2
    v_exp_f32 v131, v131
    v_exp_f32 v132, v132
    v_exp_f32 v133, v133
    v_exp_f32 v134, v134
    v_exp_f32 v135, v135
    v_exp_f32 v104, v104
    v_exp_f32 v105, v105
    v_smfmac_f32_32x32x32_bf16 v[136:151], v[84:87], v[128:135], v2
    v_exp_f32 v106, v106
    v_exp_f32 v107, v107
    v_exp_f32 v108, v108
    s_waitcnt vmcnt(1)
    v_mfma_f32_32x32x16_bf16 v[120:135], v[36:39], v[4:7], 0
    v_permlane16_swap_b32 v88, v92
    v_exp_f32 v109, v109
    v_permlane16_swap_b32 v89, v93
    v_exp_f32 v110, v110
    v_permlane16_swap_b32 v90, v94
    v_exp_f32 v111, v111
    v_permlane16_swap_b32 v91, v95
    v_exp_f32 v112, v112
    v_exp_f32 v113, v113
    v_exp_f32 v114, v114
    v_smfmac_f32_32x32x32_bf16 v[136:151], v[88:91], v[104:111], v2
    v_exp_f32 v115, v115
    v_exp_f32 v116, v116
    v_exp_f32 v117, v117
    v_exp_f32 v118, v118
    v_exp_f32 v119, v119
    v_exp_f32 v120, v120
    v_exp_f32 v121, v121
    v_smfmac_f32_32x32x32_bf16 v[136:151], v[92:95], v[112:119], v2
    s_branch QW
QWRET:
    v_exp_f32 v122, v122
    v_exp_f32 v123, v123
    v_exp_f32 v124, v124
    s_waitcnt vmcnt(0) lgkmcnt(0)
    v_mfma_f32_32x32x16_bf16 v[104:119], v[8:11], v[4:7], 0
    v_permlane16_swap_b32 v96, v100
    v_exp_f32 v125, v125
    v_permlane16_swap_b32 v97, v101
    v_exp_f32 v126, v126
    v_permlane16_swap_b32 v98, v102
    v_exp_f32 v127, v127
    v_permlane16_swap_b32 v99, v103
    v_exp_f32 v128, v128
    v_exp_f32 v129, v129
    v_exp_f32 v130, v130
    v_smfmac_f32_32x32x32_bf16 v[136:151], v[96:99], v[120:127], v2
    v_exp_f32 v131, v131
    v_exp_f32 v132, v132
    v_exp_f32 v133, v133
    v_exp_f32 v134, v134
    v_exp_f32 v135, v135
    v_exp_f32 v104, v104
    v_exp_f32 v105, v105
    v_smfmac_f32_32x32x32_bf16 v[136:151], v[100:103], v[128:135], v2
    v_exp_f32 v106, v106
    v_exp_f32 v107, v107
    v_exp_f32 v108, v108
    v_mfma_f32_32x32x16_bf16 v[120:135], v[12:15], v[4:7], 0
    v_exp_f32 v109, v109
    v_exp_f32 v110, v110
    v_exp_f32 v111, v111
    v_exp_f32 v112, v112
    v_exp_f32 v113, v113
    v_exp_f32 v114, v114
    v_smfmac_f32_32x32x32_bf16 v[152:167], v[40:43], v[104:111], v2
    v_exp_f32 v115, v115
    v_exp_f32 v116, v116
    v_exp_f32 v117, v117
    v_exp_f32 v118, v118
    v_exp_f32 v119, v119
    v_exp_f32 v120, v120
    v_exp_f32 v121, v121
    v_smfmac_f32_32x32x32_bf16 v[152:167], v[44:47], v[112:119], v2
    v_exp_f32 v122, v122
    ds_write_b128 v1, v[136:139] offset:0
    v_exp_f32 v123, v123
    ds_write_b128 v1, v[140:143] offset:1024
    v_exp_f32 v124, v124
    v_mfma_f32_32x32x16_bf16 v[104:119], v[16:19], v[4:7], 0
    ds_write_addtid_b32 v144 offset:0
    v_exp_f32 v125, v125
    ds_add_u32 v3, v2 offset:58368
    v_exp_f32 v126, v126
    v_exp_f32 v127, v127
    v_exp_f32 v128, v128
    v_exp_f32 v129, v129
    v_exp_f32 v130, v130
    v_smfmac_f32_32x32x32_bf16 v[152:167], v[48:51], v[120:127], v2
    v_exp_f32 v131, v131
    v_exp_f32 v132, v132
    v_exp_f32 v133, v133
    v_exp_f32 v134, v134
    v_exp_f32 v135, v135
    v_exp_f32 v104, v104
    v_exp_f32 v105, v105
    v_smfmac_f32_32x32x32_bf16 v[152:167], v[52:55], v[128:135], v2
    v_exp_f32 v106, v106
    ds_read_b128 v[136:139], v2 offset:7715
    v_exp_f32 v107, v107
    ds_read_b128 v[140:143], v2 offset:7715
    v_exp_f32 v108, v108
    v_mfma_f32_32x32x16_bf16 v[120:135], v[20:23], v[4:7], 0
    v_exp_f32 v109, v109
    ds_read_b32 v144, v2 offset:7715
    v_exp_f32 v110, v110
    v_exp_f32 v111, v111
    v_exp_f32 v112, v112
    v_exp_f32 v113, v113
    v_exp_f32 v114, v114
    v_smfmac_f32_32x32x32_bf16 v[152:167], v[56:59], v[104:111], v2
    v_exp_f32 v115, v115
    v_exp_f32 v116, v116
    v_exp_f32 v117, v117
    v_exp_f32 v118, v118
    v_exp_f32 v119, v119
    v_exp_f32 v120, v120
    v_exp_f32 v121, v121
    v_smfmac_f32_32x32x32_bf16 v[152:167], v[60:63], v[112:119], v2
    v_exp_f32 v122, v122
    v_exp_f32 v123, v123
    v_exp_f32 v124, v124
    v_mfma_f32_32x32x16_bf16 v[104:119], v[24:27], v[4:7], 0
    v_exp_f32 v125, v125
    v_exp_f32 v126, v126
    v_exp_f32 v127, v127
    v_exp_f32 v128, v128
    v_exp_f32 v129, v129
    v_exp_f32 v130, v130
    v_smfmac_f32_32x32x32_bf16 v[152:167], v[64:67], v[120:127], v2
    v_exp_f32 v131, v131
    v_exp_f32 v132, v132
    v_exp_f32 v133, v133
    v_exp_f32 v134, v134
    v_exp_f32 v135, v135
    v_exp_f32 v104, v104
    v_exp_f32 v105, v105
    v_smfmac_f32_32x32x32_bf16 v[152:167], v[68:71], v[128:135], v2
    v_exp_f32 v106, v106
    v_exp_f32 v107, v107
    v_exp_f32 v108, v108
    v_mfma_f32_32x32x16_bf16 v[120:135], v[28:31], v[4:7], 0
    v_exp_f32 v109, v109
    v_exp_f32 v110, v110
    v_exp_f32 v111, v111
    v_exp_f32 v112, v112
    v_exp_f32 v113, v113
    v_exp_f32 v114, v114
    v_smfmac_f32_32x32x32_bf16 v[152:167], v[72:75], v[104:111], v2
    v_exp_f32 v115, v115
    v_exp_f32 v116, v116
    v_exp_f32 v117, v117
    v_exp_f32 v118, v118
    v_exp_f32 v119, v119
    v_exp_f32 v120, v120
    v_exp_f32 v121, v121
    v_smfmac_f32_32x32x32_bf16 v[152:167], v[76:79], v[112:119], v2
    v_exp_f32 v122, v122
    v_exp_f32 v123, v123
    v_exp_f32 v124, v124
    v_mfma_f32_32x32x16_bf16 v[104:119], v[32:35], v[4:7], 0
    v_exp_f32 v125, v125
    v_exp_f32 v126, v126
    v_exp_f32 v127, v127
    v_exp_f32 v128, v128
    v_exp_f32 v129, v129
    v_exp_f32 v130, v130
    v_smfmac_f32_32x32x32_bf16 v[152:167], v[80:83], v[120:127], v2
    v_exp_f32 v131, v131
    v_exp_f32 v132, v132
    v_exp_f32 v133, v133
    v_exp_f32 v134, v134
    v_exp_f32 v135, v135
    v_exp_f32 v104, v104
    v_exp_f32 v105, v105
    v_smfmac_f32_32x32x32_bf16 v[152:167], v[84:87], v[128:135], v2
    v_exp_f32 v106, v106
    v_exp_f32 v107, v107
    v_exp_f32 v108, v108
    v_mfma_f32_32x32x16_bf16 v[120:135], v[36:39], v[4:7], 0
    v_exp_f32 v109, v109
    ds_read_b128 v[4:7], v0 offset:14336
    v_exp_f32 v110, v110
    v_exp_f32 v111, v111
    v_exp_f32 v112, v112
    v_exp_f32 v113, v113
    v_exp_f32 v114, v114
    v_smfmac_f32_32x32x32_bf16 v[152:167], v[88:91], v[104:111], v2
    v_exp_f32 v115, v115
    v_exp_f32 v116, v116
    v_exp_f32 v117, v117
    v_exp_f32 v118, v118
    v_exp_f32 v119, v119
    v_exp_f32 v120, v120
    v_exp_f32 v121, v121
    v_smfmac_f32_32x32x32_bf16 v[152:167], v[92:95], v[112:119], v2
    v_exp_f32 v122, v122
    v_exp_f32 v123, v123
    v_exp_f32 v124, v124
    s_waitcnt lgkmcnt(0)
    v_mfma_f32_32x32x16_bf16 v[104:119], v[8:11], v[4:7], 0
    v_exp_f32 v125, v125
    v_exp_f32 v126, v126
    v_exp_f32 v127, v127
    v_exp_f32 v128, v128
    v_exp_f32 v129, v129
    v_exp_f32 v130, v130
    v_smfmac_f32_32x32x32_bf16 v[152:167], v[96:99], v[120:127], v2
    v_exp_f32 v131, v131
    v_exp_f32 v132, v132
    v_exp_f32 v133, v133
    v_exp_f32 v134, v134
    v_exp_f32 v135, v135
    v_exp_f32 v104, v104
    v_exp_f32 v105, v105
    v_smfmac_f32_32x32x32_bf16 v[152:167], v[100:103], v[128:135], v2
    v_exp_f32 v106, v106
    v_exp_f32 v107, v107
    v_exp_f32 v108, v108
    v_mfma_f32_32x32x16_bf16 v[120:135], v[12:15], v[4:7], 0
    v_exp_f32 v109, v109
    v_exp_f32 v110, v110
    v_exp_f32 v111, v111
    v_exp_f32 v112, v112
    v_exp_f32 v113, v113
    v_exp_f32 v114, v114
    v_smfmac_f32_32x32x32_bf16 v[136:151], v[40:43], v[104:111], v2
    v_exp_f32 v115, v115
    v_exp_f32 v116, v116
    v_exp_f32 v117, v117
    v_exp_f32 v118, v118
    v_exp_f32 v119, v119
    v_exp_f32 v120, v120
    v_exp_f32 v121, v121
    v_smfmac_f32_32x32x32_bf16 v[136:151], v[44:47], v[112:119], v2
    v_exp_f32 v122, v122
    ds_write_b128 v1, v[152:155] offset:16384
    v_exp_f32 v123, v123
    ds_write_b128 v1, v[156:159] offset:17408
    v_exp_f32 v124, v124
    v_mfma_f32_32x32x16_bf16 v[104:119], v[16:19], v[4:7], 0
    ds_write_addtid_b32 v160 offset:2048
    v_exp_f32 v125, v125
    ds_add_u32 v3, v2 offset:58624
    v_exp_f32 v126, v126
    v_exp_f32 v127, v127
    v_exp_f32 v128, v128
    v_exp_f32 v129, v129
    v_exp_f32 v130, v130
    v_smfmac_f32_32x32x32_bf16 v[136:151], v[48:51], v[120:127], v2
    v_exp_f32 v131, v131
    v_exp_f32 v132, v132
    v_exp_f32 v133, v133
    v_exp_f32 v134, v134
    v_exp_f32 v135, v135
    v_exp_f32 v104, v104
    v_exp_f32 v105, v105
    v_smfmac_f32_32x32x32_bf16 v[136:151], v[52:55], v[128:135], v2
    v_exp_f32 v106, v106
    ds_read_b128 v[152:155], v2 offset:7715
    v_exp_f32 v107, v107
    ds_read_b128 v[156:159], v2 offset:7715
    v_exp_f32 v108, v108
    v_mfma_f32_32x32x16_bf16 v[120:135], v[20:23], v[4:7], 0
    v_exp_f32 v109, v109
    ds_read_b32 v160, v2 offset:7715
    v_exp_f32 v110, v110
    v_exp_f32 v111, v111
    v_exp_f32 v112, v112
    v_exp_f32 v113, v113
    v_exp_f32 v114, v114
    v_smfmac_f32_32x32x32_bf16 v[136:151], v[56:59], v[104:111], v2
    v_exp_f32 v115, v115
    v_exp_f32 v116, v116
    v_exp_f32 v117, v117
    v_exp_f32 v118, v118
    v_exp_f32 v119, v119
    v_exp_f32 v120, v120
    v_exp_f32 v121, v121
    v_smfmac_f32_32x32x32_bf16 v[136:151], v[60:63], v[112:119], v2
    v_exp_f32 v122, v122
    v_exp_f32 v123, v123
    v_exp_f32 v124, v124
    v_mfma_f32_32x32x16_bf16 v[104:119], v[24:27], v[4:7], 0
    v_exp_f32 v125, v125
    v_exp_f32 v126, v126
    v_exp_f32 v127, v127
    v_exp_f32 v128, v128
    v_exp_f32 v129, v129
    v_exp_f32 v130, v130
    v_smfmac_f32_32x32x32_bf16 v[136:151], v[64:67], v[120:127], v2
    v_exp_f32 v131, v131
    v_exp_f32 v132, v132
    v_exp_f32 v133, v133
    v_exp_f32 v134, v134
    v_exp_f32 v135, v135
    v_exp_f32 v104, v104
    v_exp_f32 v105, v105
    v_smfmac_f32_32x32x32_bf16 v[136:151], v[68:71], v[128:135], v2
    v_exp_f32 v106, v106
    v_exp_f32 v107, v107
    v_exp_f32 v108, v108
    v_mfma_f32_32x32x16_bf16 v[120:135], v[28:31], v[4:7], 0
    v_exp_f32 v109, v109
    v_exp_f32 v110, v110
    v_exp_f32 v111, v111
    v_exp_f32 v112, v112
    v_exp_f32 v113, v113
    v_exp_f32 v114, v114
    v_smfmac_f32_32x32x32_bf16 v[136:151], v[72:75], v[104:111], v2
    v_exp_f32 v115, v115
    v_exp_f32 v116, v116
    v_exp_f32 v117, v117
    v_exp_f32 v118, v118
    v_exp_f32 v119, v119
    v_exp_f32 v120, v120
    v_exp_f32 v121, v121
    v_smfmac_f32_32x32x32_bf16 v[136:151], v[76:79], v[112:119], v2
    v_exp_f32 v122, v122
    v_exp_f32 v123, v123
    v_exp_f32 v124, v124
    v_mfma_f32_32x32x16_bf16 v[104:119], v[32:35], v[4:7], 0
    v_exp_f32 v125, v125
    v_exp_f32 v126, v126
    v_exp_f32 v127, v127
    v_exp_f32 v128, v128
    v_exp_f32 v129, v129
    v_exp_f32 v130, v130
    v_smfmac_f32_32x32x32_bf16 v[136:151], v[80:83], v[120:127], v2
    v_exp_f32 v131, v131
    v_exp_f32 v132, v132
    v_exp_f32 v133, v133
    v_exp_f32 v134, v134
    v_exp_f32 v135, v135
    v_exp_f32 v104, v104
    v_exp_f32 v105, v105
    v_smfmac_f32_32x32x32_bf16 v[136:151], v[84:87], v[128:135], v2
    v_exp_f32 v106, v106
    v_exp_f32 v107, v107
    v_exp_f32 v108, v108
    v_mfma_f32_32x32x16_bf16 v[120:135], v[36:39], v[4:7], 0
    v_exp_f32 v109, v109
    ds_read_b128 v[4:7], v0 offset:15360
    v_exp_f32 v110, v110
    v_exp_f32 v111, v111
    v_exp_f32 v112, v112
    v_exp_f32 v113, v113
    v_exp_f32 v114, v114
    v_smfmac_f32_32x32x32_bf16 v[136:151], v[88:91], v[104:111], v2
    v_exp_f32 v115, v115
    v_exp_f32 v116, v116
    v_exp_f32 v117, v117
    v_exp_f32 v118, v118
    v_exp_f32 v119, v119
    v_exp_f32 v120, v120
    v_exp_f32 v121, v121
    v_smfmac_f32_32x32x32_bf16 v[136:151], v[92:95], v[112:119], v2
    v_exp_f32 v122, v122
    v_exp_f32 v123, v123
    v_exp_f32 v124, v124
    s_waitcnt lgkmcnt(0)
    v_mfma_f32_32x32x16_bf16 v[104:119], v[8:11], v[4:7], 0
    v_exp_f32 v125, v125
    v_exp_f32 v126, v126
    v_exp_f32 v127, v127
    v_exp_f32 v128, v128
    v_exp_f32 v129, v129
    v_exp_f32 v130, v130
    v_smfmac_f32_32x32x32_bf16 v[136:151], v[96:99], v[120:127], v2
    v_exp_f32 v131, v131
    v_exp_f32 v132, v132
    v_exp_f32 v133, v133
    v_exp_f32 v134, v134
    v_exp_f32 v135, v135
    v_exp_f32 v104, v104
    v_exp_f32 v105, v105
    v_smfmac_f32_32x32x32_bf16 v[136:151], v[100:103], v[128:135], v2
    v_exp_f32 v106, v106
    v_exp_f32 v107, v107
    v_exp_f32 v108, v108
    v_mfma_f32_32x32x16_bf16 v[120:135], v[12:15], v[4:7], 0
    v_exp_f32 v109, v109
    v_exp_f32 v110, v110
    v_exp_f32 v111, v111
    v_exp_f32 v112, v112
    v_exp_f32 v113, v113
    v_exp_f32 v114, v114
    v_smfmac_f32_32x32x32_bf16 v[152:167], v[40:43], v[104:111], v2
    v_exp_f32 v115, v115
    v_exp_f32 v116, v116
    v_exp_f32 v117, v117
    v_exp_f32 v118, v118
    v_exp_f32 v119, v119
    v_exp_f32 v120, v120
    v_exp_f32 v121, v121
    v_smfmac_f32_32x32x32_bf16 v[152:167], v[44:47], v[112:119], v2
    v_exp_f32 v122, v122
    ds_write_b128 v1, v[136:139] offset:32768
    v_exp_f32 v123, v123
    ds_write_b128 v1, v[140:143] offset:33792
    v_exp_f32 v124, v124
    v_mfma_f32_32x32x16_bf16 v[104:119], v[16:19], v[4:7], 0
    ds_write_addtid_b32 v144 offset:4096
    v_exp_f32 v125, v125
    ds_add_u32 v3, v2 offset:58880
    v_exp_f32 v126, v126
    v_exp_f32 v127, v127
    v_exp_f32 v128, v128
    v_exp_f32 v129, v129
    v_exp_f32 v130, v130
    v_smfmac_f32_32x32x32_bf16 v[152:167], v[48:51], v[120:127], v2
    v_exp_f32 v131, v131
    v_exp_f32 v132, v132
    v_exp_f32 v133, v133
    v_exp_f32 v134, v134
    v_exp_f32 v135, v135
    v_exp_f32 v104, v104
    v_exp_f32 v105, v105
    v_smfmac_f32_32x32x32_bf16 v[152:167], v[52:55], v[128:135], v2
    v_exp_f32 v106, v106
    ds_read_b128 v[136:139], v2 offset:7715
    v_exp_f32 v107, v107
    ds_read_b128 v[140:143], v2 offset:7715
    v_exp_f32 v108, v108
    v_mfma_f32_32x32x16_bf16 v[120:135], v[20:23], v[4:7], 0
    v_exp_f32 v109, v109
    ds_read_b32 v144, v2 offset:7715
    v_exp_f32 v110, v110
    v_exp_f32 v111, v111
    v_exp_f32 v112, v112
    v_exp_f32 v113, v113
    v_exp_f32 v114, v114
    v_smfmac_f32_32x32x32_bf16 v[152:167], v[56:59], v[104:111], v2
    v_exp_f32 v115, v115
    v_exp_f32 v116, v116
    v_exp_f32 v117, v117
    v_exp_f32 v118, v118
    v_exp_f32 v119, v119
    v_exp_f32 v120, v120
    v_exp_f32 v121, v121
    v_smfmac_f32_32x32x32_bf16 v[152:167], v[60:63], v[112:119], v2
    v_exp_f32 v122, v122
    v_exp_f32 v123, v123
    v_exp_f32 v124, v124
    v_mfma_f32_32x32x16_bf16 v[104:119], v[24:27], v[4:7], 0
    v_exp_f32 v125, v125
    v_exp_f32 v126, v126
    v_exp_f32 v127, v127
    v_exp_f32 v128, v128
    v_exp_f32 v129, v129
    v_exp_f32 v130, v130
    v_smfmac_f32_32x32x32_bf16 v[152:167], v[64:67], v[120:127], v2
    v_exp_f32 v131, v131
    v_exp_f32 v132, v132
    v_exp_f32 v133, v133
    v_exp_f32 v134, v134
    v_exp_f32 v135, v135
    v_exp_f32 v104, v104
    v_exp_f32 v105, v105
    v_smfmac_f32_32x32x32_bf16 v[152:167], v[68:71], v[128:135], v2
    v_exp_f32 v106, v106
    v_exp_f32 v107, v107
    v_exp_f32 v108, v108
    v_mfma_f32_32x32x16_bf16 v[120:135], v[28:31], v[4:7], 0
    v_exp_f32 v109, v109
    v_exp_f32 v110, v110
    v_exp_f32 v111, v111
    v_exp_f32 v112, v112
    v_exp_f32 v113, v113
    v_exp_f32 v114, v114
    v_smfmac_f32_32x32x32_bf16 v[152:167], v[72:75], v[104:111], v2
    v_exp_f32 v115, v115
    v_exp_f32 v116, v116
    v_exp_f32 v117, v117
    v_exp_f32 v118, v118
    v_exp_f32 v119, v119
    v_exp_f32 v120, v120
    v_exp_f32 v121, v121
    v_smfmac_f32_32x32x32_bf16 v[152:167], v[76:79], v[112:119], v2
    v_exp_f32 v122, v122
    v_exp_f32 v123, v123
    v_exp_f32 v124, v124
    v_mfma_f32_32x32x16_bf16 v[104:119], v[32:35], v[4:7], 0
    v_exp_f32 v125, v125
    v_exp_f32 v126, v126
    v_exp_f32 v127, v127
    v_exp_f32 v128, v128
    v_exp_f32 v129, v129
    v_exp_f32 v130, v130
    v_smfmac_f32_32x32x32_bf16 v[152:167], v[80:83], v[120:127], v2
    v_exp_f32 v131, v131
    v_exp_f32 v132, v132
    v_exp_f32 v133, v133
    v_exp_f32 v134, v134
    v_exp_f32 v135, v135
    v_exp_f32 v104, v104
    v_exp_f32 v105, v105
    v_smfmac_f32_32x32x32_bf16 v[152:167], v[84:87], v[128:135], v2
    v_exp_f32 v106, v106
    v_exp_f32 v107, v107
    v_exp_f32 v108, v108
    v_mfma_f32_32x32x16_bf16 v[120:135], v[36:39], v[4:7], 0
    v_exp_f32 v109, v109
    ds_read_b128 v[4:7], v0 offset:16384
    v_exp_f32 v110, v110
    v_exp_f32 v111, v111
    v_exp_f32 v112, v112
    v_exp_f32 v113, v113
    v_exp_f32 v114, v114
    v_smfmac_f32_32x32x32_bf16 v[152:167], v[88:91], v[104:111], v2
    v_exp_f32 v115, v115
    v_exp_f32 v116, v116
    v_exp_f32 v117, v117
    v_exp_f32 v118, v118
    v_exp_f32 v119, v119
    v_exp_f32 v120, v120
    v_exp_f32 v121, v121
    v_smfmac_f32_32x32x32_bf16 v[152:167], v[92:95], v[112:119], v2
    v_exp_f32 v122, v122
    v_exp_f32 v123, v123
    v_exp_f32 v124, v124
    s_waitcnt lgkmcnt(0)
    v_mfma_f32_32x32x16_bf16 v[104:119], v[8:11], v[4:7], 0
    v_exp_f32 v125, v125
    v_exp_f32 v126, v126
    v_exp_f32 v127, v127
    v_exp_f32 v128, v128
    v_exp_f32 v129, v129
    v_exp_f32 v130, v130
    v_smfmac_f32_32x32x32_bf16 v[152:167], v[96:99], v[120:127], v2
    v_exp_f32 v131, v131
    v_exp_f32 v132, v132
    v_exp_f32 v133, v133
    v_exp_f32 v134, v134
    v_exp_f32 v135, v135
    v_exp_f32 v104, v104
    v_exp_f32 v105, v105
    v_smfmac_f32_32x32x32_bf16 v[152:167], v[100:103], v[128:135], v2
    v_exp_f32 v106, v106
    v_exp_f32 v107, v107
    v_exp_f32 v108, v108
    v_mfma_f32_32x32x16_bf16 v[120:135], v[12:15], v[4:7], 0
    v_exp_f32 v109, v109
    v_exp_f32 v110, v110
    v_exp_f32 v111, v111
    v_exp_f32 v112, v112
    v_exp_f32 v113, v113
    v_exp_f32 v114, v114
    v_smfmac_f32_32x32x32_bf16 v[136:151], v[40:43], v[104:111], v2
    v_exp_f32 v115, v115
    v_exp_f32 v116, v116
    v_exp_f32 v117, v117
    v_exp_f32 v118, v118
    v_exp_f32 v119, v119
    v_exp_f32 v120, v120
    v_exp_f32 v121, v121
    v_smfmac_f32_32x32x32_bf16 v[136:151], v[44:47], v[112:119], v2
    v_exp_f32 v122, v122
    ds_write_b128 v1, v[152:155] offset:49152
    v_exp_f32 v123, v123
    ds_write_b128 v1, v[156:159] offset:50176
    v_exp_f32 v124, v124
    v_mfma_f32_32x32x16_bf16 v[104:119], v[16:19], v[4:7], 0
    ds_write_addtid_b32 v160 offset:6144
    v_exp_f32 v125, v125
    ds_add_u32 v3, v2 offset:59136
    v_exp_f32 v126, v126
    s_setprio 2
    v_exp_f32 v127, v127
    v_exp_f32 v128, v128
    v_exp_f32 v129, v129
    v_exp_f32 v130, v130
    v_smfmac_f32_32x32x32_bf16 v[136:151], v[48:51], v[120:127], v2
    v_exp_f32 v131, v131
    v_exp_f32 v132, v132
    v_exp_f32 v133, v133
    v_exp_f32 v134, v134
    v_exp_f32 v135, v135
    v_exp_f32 v104, v104
    v_exp_f32 v105, v105
    v_smfmac_f32_32x32x32_bf16 v[136:151], v[52:55], v[128:135], v2
    v_exp_f32 v106, v106
    ds_read_b128 v[152:155], v2 offset:7715
    v_exp_f32 v107, v107
    ds_read_b128 v[156:159], v2 offset:7715
    v_exp_f32 v108, v108
    v_mfma_f32_32x32x16_bf16 v[120:135], v[20:23], v[4:7], 0
    v_exp_f32 v109, v109
    ds_read_b32 v160, v2 offset:7715
    v_exp_f32 v110, v110
    v_exp_f32 v111, v111
    v_exp_f32 v112, v112
    v_exp_f32 v113, v113
    v_exp_f32 v114, v114
    v_smfmac_f32_32x32x32_bf16 v[136:151], v[56:59], v[104:111], v2
    v_exp_f32 v115, v115
    v_exp_f32 v116, v116
    v_exp_f32 v117, v117
    v_exp_f32 v118, v118
    v_exp_f32 v119, v119
    v_exp_f32 v120, v120
    v_exp_f32 v121, v121
    v_smfmac_f32_32x32x32_bf16 v[136:151], v[60:63], v[112:119], v2
    v_exp_f32 v122, v122
    v_exp_f32 v123, v123
    v_exp_f32 v124, v124
    v_mfma_f32_32x32x16_bf16 v[104:119], v[24:27], v[4:7], 0
    v_exp_f32 v125, v125
    v_exp_f32 v126, v126
    v_exp_f32 v127, v127
    v_exp_f32 v128, v128
    v_exp_f32 v129, v129
    v_exp_f32 v130, v130
    v_smfmac_f32_32x32x32_bf16 v[136:151], v[64:67], v[120:127], v2
    v_exp_f32 v131, v131
    v_exp_f32 v132, v132
    v_exp_f32 v133, v133
    v_exp_f32 v134, v134
    v_exp_f32 v135, v135
    v_exp_f32 v104, v104
    v_exp_f32 v105, v105
    v_smfmac_f32_32x32x32_bf16 v[136:151], v[68:71], v[128:135], v2
    v_exp_f32 v106, v106
    v_exp_f32 v107, v107
    v_exp_f32 v108, v108
    v_mfma_f32_32x32x16_bf16 v[120:135], v[28:31], v[4:7], 0
    v_exp_f32 v109, v109
    v_exp_f32 v110, v110
    v_exp_f32 v111, v111
    v_exp_f32 v112, v112
    v_exp_f32 v113, v113
    v_exp_f32 v114, v114
    v_smfmac_f32_32x32x32_bf16 v[136:151], v[72:75], v[104:111], v2
    v_exp_f32 v115, v115
    v_exp_f32 v116, v116
    v_exp_f32 v117, v117
    v_exp_f32 v118, v118
    v_exp_f32 v119, v119
    v_exp_f32 v120, v120
    v_exp_f32 v121, v121
    v_smfmac_f32_32x32x32_bf16 v[136:151], v[76:79], v[112:119], v2
    v_exp_f32 v122, v122
    v_exp_f32 v123, v123
    v_exp_f32 v124, v124
    v_mfma_f32_32x32x16_bf16 v[104:119], v[32:35], v[4:7], 0
    v_exp_f32 v125, v125
    v_exp_f32 v126, v126
    v_exp_f32 v127, v127
    v_exp_f32 v128, v128
    v_exp_f32 v129, v129
    v_exp_f32 v130, v130
    v_smfmac_f32_32x32x32_bf16 v[136:151], v[80:83], v[120:127], v2
    v_exp_f32 v131, v131
    v_exp_f32 v132, v132
    v_exp_f32 v133, v133
    v_exp_f32 v134, v134
    v_exp_f32 v135, v135
    v_exp_f32 v104, v104
    v_exp_f32 v105, v105
    v_smfmac_f32_32x32x32_bf16 v[136:151], v[84:87], v[128:135], v2
    v_exp_f32 v106, v106
    v_exp_f32 v107, v107
    v_exp_f32 v108, v108
    v_mfma_f32_32x32x16_bf16 v[120:135], v[36:39], v[4:7], 0
    v_exp_f32 v109, v109
    ds_read_b128 v[4:7], v0 offset:17408
    v_exp_f32 v110, v110
    v_exp_f32 v111, v111
    v_exp_f32 v112, v112
    v_exp_f32 v113, v113
    v_exp_f32 v114, v114
    v_smfmac_f32_32x32x32_bf16 v[136:151], v[88:91], v[104:111], v2
    v_exp_f32 v115, v115
    v_exp_f32 v116, v116
    v_exp_f32 v117, v117
    v_exp_f32 v118, v118
    v_exp_f32 v119, v119
    v_exp_f32 v120, v120
    v_exp_f32 v121, v121
    v_smfmac_f32_32x32x32_bf16 v[136:151], v[92:95], v[112:119], v2
    v_exp_f32 v122, v122
    v_exp_f32 v123, v123
    v_exp_f32 v124, v124
    s_waitcnt lgkmcnt(0)
    v_mfma_f32_32x32x16_bf16 v[104:119], v[8:11], v[4:7], 0
    v_exp_f32 v125, v125
    v_exp_f32 v126, v126
    v_exp_f32 v127, v127
    v_exp_f32 v128, v128
    v_exp_f32 v129, v129
    v_exp_f32 v130, v130
    v_smfmac_f32_32x32x32_bf16 v[136:151], v[96:99], v[120:127], v2
    v_exp_f32 v131, v131
    v_exp_f32 v132, v132
    v_exp_f32 v133, v133
    v_exp_f32 v134, v134
    v_exp_f32 v135, v135
    v_exp_f32 v104, v104
    v_exp_f32 v105, v105
    v_smfmac_f32_32x32x32_bf16 v[136:151], v[100:103], v[128:135], v2
    v_exp_f32 v106, v106
    v_exp_f32 v107, v107
    v_exp_f32 v108, v108
    v_mfma_f32_32x32x16_bf16 v[120:135], v[12:15], v[4:7], 0
    v_exp_f32 v109, v109
    v_exp_f32 v110, v110
    v_exp_f32 v111, v111
    v_exp_f32 v112, v112
    v_exp_f32 v113, v113
    v_exp_f32 v114, v114
    v_smfmac_f32_32x32x32_bf16 v[152:167], v[40:43], v[104:111], v2
    v_exp_f32 v115, v115
    v_exp_f32 v116, v116
    v_exp_f32 v117, v117
    v_exp_f32 v118, v118
    ds_read_b32 v146, v3 offset:60416
    v_exp_f32 v119, v119
    v_exp_f32 v120, v120
    v_exp_f32 v121, v121
    v_smfmac_f32_32x32x32_bf16 v[152:167], v[44:47], v[112:119], v2
    s_waitcnt lgkmcnt(0)
    v_cmp_ne_u32 vcc, 1, v146
    s_cbranch_vccnz BP4
BPR4:
    v_exp_f32 v122, v122
    ds_write_b128 v1, v[136:139] offset:0
    v_exp_f32 v123, v123
    ds_write_b128 v1, v[140:143] offset:1024
    v_exp_f32 v124, v124
    v_mfma_f32_32x32x16_bf16 v[104:119], v[16:19], v[4:7], 0
    ds_write_addtid_b32 v144 offset:0
    v_exp_f32 v125, v125
    ds_add_u32 v3, v2 offset:59392
    v_exp_f32 v126, v126
    v_exp_f32 v127, v127
    v_exp_f32 v128, v128
    v_exp_f32 v129, v129
    v_exp_f32 v130, v130
    v_smfmac_f32_32x32x32_bf16 v[152:167], v[48:51], v[120:127], v2
    v_exp_f32 v131, v131
    v_exp_f32 v132, v132
    v_exp_f32 v133, v133
    v_exp_f32 v134, v134
    v_exp_f32 v135, v135
    v_exp_f32 v104, v104
    v_exp_f32 v105, v105
    v_smfmac_f32_32x32x32_bf16 v[152:167], v[52:55], v[128:135], v2
    v_exp_f32 v106, v106
    ds_read_b128 v[136:139], v2 offset:7715
    v_exp_f32 v107, v107
    ds_read_b128 v[140:143], v2 offset:7715
    v_exp_f32 v108, v108
    v_mfma_f32_32x32x16_bf16 v[120:135], v[20:23], v[4:7], 0
    v_exp_f32 v109, v109
    ds_read_b32 v144, v2 offset:7715
    v_exp_f32 v110, v110
    v_exp_f32 v111, v111
    v_exp_f32 v112, v112
    v_exp_f32 v113, v113
    v_exp_f32 v114, v114
    v_smfmac_f32_32x32x32_bf16 v[152:167], v[56:59], v[104:111], v2
    v_exp_f32 v115, v115
    v_exp_f32 v116, v116
    v_exp_f32 v117, v117
    v_exp_f32 v118, v118
    v_exp_f32 v119, v119
    v_exp_f32 v120, v120
    v_exp_f32 v121, v121
    v_smfmac_f32_32x32x32_bf16 v[152:167], v[60:63], v[112:119], v2
    v_exp_f32 v122, v122
    v_exp_f32 v123, v123
    v_exp_f32 v124, v124
    v_mfma_f32_32x32x16_bf16 v[104:119], v[24:27], v[4:7], 0
    v_exp_f32 v125, v125
    v_exp_f32 v126, v126
    v_exp_f32 v127, v127
    v_exp_f32 v128, v128
    v_exp_f32 v129, v129
    v_exp_f32 v130, v130
    v_smfmac_f32_32x32x32_bf16 v[152:167], v[64:67], v[120:127], v2
    v_exp_f32 v131, v131
    v_exp_f32 v132, v132
    v_exp_f32 v133, v133
    v_exp_f32 v134, v134
    v_exp_f32 v135, v135
    v_exp_f32 v104, v104
    v_exp_f32 v105, v105
    v_smfmac_f32_32x32x32_bf16 v[152:167], v[68:71], v[128:135], v2
    v_exp_f32 v106, v106
    v_exp_f32 v107, v107
    v_exp_f32 v108, v108
    v_mfma_f32_32x32x16_bf16 v[120:135], v[28:31], v[4:7], 0
    v_exp_f32 v109, v109
    v_exp_f32 v110, v110
    v_exp_f32 v111, v111
    v_exp_f32 v112, v112
    v_exp_f32 v113, v113
    v_exp_f32 v114, v114
    v_smfmac_f32_32x32x32_bf16 v[152:167], v[72:75], v[104:111], v2
    v_exp_f32 v115, v115
    v_exp_f32 v116, v116
    v_exp_f32 v117, v117
    v_exp_f32 v118, v118
    v_exp_f32 v119, v119
    v_exp_f32 v120, v120
    v_exp_f32 v121, v121
    v_smfmac_f32_32x32x32_bf16 v[152:167], v[76:79], v[112:119], v2
    v_exp_f32 v122, v122
    v_exp_f32 v123, v123
    v_exp_f32 v124, v124
    v_mfma_f32_32x32x16_bf16 v[104:119], v[32:35], v[4:7], 0
    v_exp_f32 v125, v125
    v_exp_f32 v126, v126
    v_exp_f32 v127, v127
    v_exp_f32 v128, v128
    v_exp_f32 v129, v129
    v_exp_f32 v130, v130
    v_smfmac_f32_32x32x32_bf16 v[152:167], v[80:83], v[120:127], v2
    v_exp_f32 v131, v131
    v_exp_f32 v132, v132
    v_exp_f32 v133, v133
    v_exp_f32 v134, v134
    v_exp_f32 v135, v135
    v_exp_f32 v104, v104
    v_exp_f32 v105, v105
    v_smfmac_f32_32x32x32_bf16 v[152:167], v[84:87], v[128:135], v2
    v_exp_f32 v106, v106
    v_exp_f32 v107, v107
    v_exp_f32 v108, v108
    v_mfma_f32_32x32x16_bf16 v[120:135], v[36:39], v[4:7], 0
    v_exp_f32 v109, v109
    ds_read_b128 v[4:7], v0 offset:18432
    v_exp_f32 v110, v110
    v_exp_f32 v111, v111
    v_exp_f32 v112, v112
    v_exp_f32 v113, v113
    v_exp_f32 v114, v114
    v_smfmac_f32_32x32x32_bf16 v[152:167], v[88:91], v[104:111], v2
    v_exp_f32 v115, v115
    v_exp_f32 v116, v116
    v_exp_f32 v117, v117
    v_exp_f32 v118, v118
    v_exp_f32 v119, v119
    v_exp_f32 v120, v120
    v_exp_f32 v121, v121
    v_smfmac_f32_32x32x32_bf16 v[152:167], v[92:95], v[112:119], v2
    v_exp_f32 v122, v122
    v_exp_f32 v123, v123
    v_exp_f32 v124, v124
    s_waitcnt lgkmcnt(0)
    v_mfma_f32_32x32x16_bf16 v[104:119], v[8:11], v[4:7], 0
    v_exp_f32 v125, v125
    v_exp_f32 v126, v126
    v_exp_f32 v127, v127
    v_exp_f32 v128, v128
    v_exp_f32 v129, v129
    v_exp_f32 v130, v130
    v_smfmac_f32_32x32x32_bf16 v[152:167], v[96:99], v[120:127], v2
    v_exp_f32 v131, v131
    v_exp_f32 v132, v132
    v_exp_f32 v133, v133
    v_exp_f32 v134, v134
    v_exp_f32 v135, v135
    v_exp_f32 v104, v104
    v_exp_f32 v105, v105
    v_smfmac_f32_32x32x32_bf16 v[152:167], v[100:103], v[128:135], v2
    v_exp_f32 v106, v106
    v_exp_f32 v107, v107
    v_exp_f32 v108, v108
    v_mfma_f32_32x32x16_bf16 v[120:135], v[12:15], v[4:7], 0
    v_exp_f32 v109, v109
    v_exp_f32 v110, v110
    v_exp_f32 v111, v111
    v_exp_f32 v112, v112
    v_exp_f32 v113, v113
    v_exp_f32 v114, v114
    v_smfmac_f32_32x32x32_bf16 v[136:151], v[40:43], v[104:111], v2
    v_exp_f32 v115, v115
    v_exp_f32 v116, v116
    v_exp_f32 v117, v117
    v_exp_f32 v118, v118
    ds_read_b32 v162, v3 offset:60672
    v_exp_f32 v119, v119
    v_exp_f32 v120, v120
    v_exp_f32 v121, v121
    v_smfmac_f32_32x32x32_bf16 v[136:151], v[44:47], v[112:119], v2
    s_waitcnt lgkmcnt(0)
    v_cmp_ne_u32 vcc, 1, v162
    s_cbranch_vccnz BP5
BPR5:
    v_exp_f32 v122, v122
    ds_write_b128 v1, v[152:155] offset:16384
    v_exp_f32 v123, v123
    ds_write_b128 v1, v[156:159] offset:17408
    v_exp_f32 v124, v124
    v_mfma_f32_32x32x16_bf16 v[104:119], v[16:19], v[4:7], 0
    ds_write_addtid_b32 v160 offset:2048
    v_exp_f32 v125, v125
    ds_add_u32 v3, v2 offset:59648
    v_exp_f32 v126, v126
    s_setprio 1
    v_exp_f32 v127, v127
    v_exp_f32 v128, v128
    v_exp_f32 v129, v129
    v_exp_f32 v130, v130
    v_smfmac_f32_32x32x32_bf16 v[136:151], v[48:51], v[120:127], v2
    v_exp_f32 v131, v131
    v_exp_f32 v132, v132
    v_exp_f32 v133, v133
    v_exp_f32 v134, v134
    v_exp_f32 v135, v135
    v_exp_f32 v104, v104
    v_exp_f32 v105, v105
    v_smfmac_f32_32x32x32_bf16 v[136:151], v[52:55], v[128:135], v2
    v_exp_f32 v106, v106
    ds_read_b128 v[152:155], v2 offset:7715
    v_exp_f32 v107, v107
    ds_read_b128 v[156:159], v2 offset:7715
    v_exp_f32 v108, v108
    v_mfma_f32_32x32x16_bf16 v[120:135], v[20:23], v[4:7], 0
    v_exp_f32 v109, v109
    ds_read_b32 v160, v2 offset:7715
    v_exp_f32 v110, v110
    v_exp_f32 v111, v111
    v_exp_f32 v112, v112
    v_exp_f32 v113, v113
    v_exp_f32 v114, v114
    v_smfmac_f32_32x32x32_bf16 v[136:151], v[56:59], v[104:111], v2
    v_exp_f32 v115, v115
    v_exp_f32 v116, v116
    v_exp_f32 v117, v117
    v_exp_f32 v118, v118
    v_exp_f32 v119, v119
    v_exp_f32 v120, v120
    v_exp_f32 v121, v121
    v_smfmac_f32_32x32x32_bf16 v[136:151], v[60:63], v[112:119], v2
    v_exp_f32 v122, v122
    v_exp_f32 v123, v123
    v_exp_f32 v124, v124
    v_mfma_f32_32x32x16_bf16 v[104:119], v[24:27], v[4:7], 0
    v_exp_f32 v125, v125
    v_exp_f32 v126, v126
    v_exp_f32 v127, v127
    v_exp_f32 v128, v128
    v_exp_f32 v129, v129
    v_exp_f32 v130, v130
    v_smfmac_f32_32x32x32_bf16 v[136:151], v[64:67], v[120:127], v2
    v_exp_f32 v131, v131
    v_exp_f32 v132, v132
    v_exp_f32 v133, v133
    v_exp_f32 v134, v134
    v_exp_f32 v135, v135
    v_exp_f32 v104, v104
    v_exp_f32 v105, v105
    v_smfmac_f32_32x32x32_bf16 v[136:151], v[68:71], v[128:135], v2
    v_exp_f32 v106, v106
    v_exp_f32 v107, v107
    v_exp_f32 v108, v108
    v_mfma_f32_32x32x16_bf16 v[120:135], v[28:31], v[4:7], 0
    v_exp_f32 v109, v109
    v_exp_f32 v110, v110
    v_exp_f32 v111, v111
    v_exp_f32 v112, v112
    v_exp_f32 v113, v113
    v_exp_f32 v114, v114
    v_smfmac_f32_32x32x32_bf16 v[136:151], v[72:75], v[104:111], v2
    v_exp_f32 v115, v115
    v_exp_f32 v116, v116
    v_exp_f32 v117, v117
    v_exp_f32 v118, v118
    v_exp_f32 v119, v119
    v_exp_f32 v120, v120
    v_exp_f32 v121, v121
    v_smfmac_f32_32x32x32_bf16 v[136:151], v[76:79], v[112:119], v2
    v_exp_f32 v122, v122
    v_exp_f32 v123, v123
    v_exp_f32 v124, v124
    v_mfma_f32_32x32x16_bf16 v[104:119], v[32:35], v[4:7], 0
    v_exp_f32 v125, v125
    v_exp_f32 v126, v126
    v_exp_f32 v127, v127
    v_exp_f32 v128, v128
    v_exp_f32 v129, v129
    v_exp_f32 v130, v130
    v_smfmac_f32_32x32x32_bf16 v[136:151], v[80:83], v[120:127], v2
    v_exp_f32 v131, v131
    v_exp_f32 v132, v132
    v_exp_f32 v133, v133
    v_exp_f32 v134, v134
    v_exp_f32 v135, v135
    v_exp_f32 v104, v104
    v_exp_f32 v105, v105
    v_smfmac_f32_32x32x32_bf16 v[136:151], v[84:87], v[128:135], v2
    v_exp_f32 v106, v106
    v_exp_f32 v107, v107
    v_exp_f32 v108, v108
    v_mfma_f32_32x32x16_bf16 v[120:135], v[36:39], v[4:7], 0
    v_exp_f32 v109, v109
    ds_read_b128 v[4:7], v0 offset:19456
    v_exp_f32 v110, v110
    v_exp_f32 v111, v111
    v_exp_f32 v112, v112
    v_exp_f32 v113, v113
    v_exp_f32 v114, v114
    v_smfmac_f32_32x32x32_bf16 v[136:151], v[88:91], v[104:111], v2
    v_exp_f32 v115, v115
    v_exp_f32 v116, v116
    v_exp_f32 v117, v117
    v_exp_f32 v118, v118
    v_exp_f32 v119, v119
    v_exp_f32 v120, v120
    v_exp_f32 v121, v121
    v_smfmac_f32_32x32x32_bf16 v[136:151], v[92:95], v[112:119], v2
    v_exp_f32 v122, v122
    v_exp_f32 v123, v123
    v_exp_f32 v124, v124
    s_waitcnt lgkmcnt(0)
    v_mfma_f32_32x32x16_bf16 v[104:119], v[8:11], v[4:7], 0
    v_exp_f32 v125, v125
    v_exp_f32 v126, v126
    v_exp_f32 v127, v127
    v_exp_f32 v128, v128
    v_exp_f32 v129, v129
    v_exp_f32 v130, v130
    v_smfmac_f32_32x32x32_bf16 v[136:151], v[96:99], v[120:127], v2
    v_exp_f32 v131, v131
    v_exp_f32 v132, v132
    v_exp_f32 v133, v133
    v_exp_f32 v134, v134
    v_exp_f32 v135, v135
    v_exp_f32 v104, v104
    v_exp_f32 v105, v105
    v_smfmac_f32_32x32x32_bf16 v[136:151], v[100:103], v[128:135], v2
    v_exp_f32 v106, v106
    v_exp_f32 v107, v107
    v_exp_f32 v108, v108
    v_mfma_f32_32x32x16_bf16 v[120:135], v[12:15], v[4:7], 0
    v_exp_f32 v109, v109
    v_exp_f32 v110, v110
    v_exp_f32 v111, v111
    v_exp_f32 v112, v112
    v_exp_f32 v113, v113
    v_exp_f32 v114, v114
    v_smfmac_f32_32x32x32_bf16 v[152:167], v[40:43], v[104:111], v2
    v_exp_f32 v115, v115
    v_exp_f32 v116, v116
    v_exp_f32 v117, v117
    v_exp_f32 v118, v118
    ds_read_b32 v146, v3 offset:60928
    v_exp_f32 v119, v119
    v_exp_f32 v120, v120
    v_exp_f32 v121, v121
    v_smfmac_f32_32x32x32_bf16 v[152:167], v[44:47], v[112:119], v2
    s_waitcnt lgkmcnt(0)
    v_cmp_ne_u32 vcc, 1, v146
    s_cbranch_vccnz BP6
BPR6:
    v_exp_f32 v122, v122
    ds_write_b128 v1, v[136:139] offset:32768
    v_exp_f32 v123, v123
    ds_write_b128 v1, v[140:143] offset:33792
    v_exp_f32 v124, v124
    v_mfma_f32_32x32x16_bf16 v[104:119], v[16:19], v[4:7], 0
    ds_write_addtid_b32 v144 offset:4096
    v_exp_f32 v125, v125
    ds_add_u32 v3, v2 offset:59904
    v_exp_f32 v126, v126
    s_setprio 0
    v_exp_f32 v127, v127
    v_exp_f32 v128, v128
    s_cmp_lt_u32 s45, 4
    s_cbranch_scc0 NOC6
    ds_add_u32 v3, v2 offset:62976
NOC6:
    v_exp_f32 v129, v129
    v_exp_f32 v130, v130
    v_smfmac_f32_32x32x32_bf16 v[152:167], v[48:51], v[120:127], v2
    v_exp_f32 v131, v131
    v_exp_f32 v132, v132
    v_exp_f32 v133, v133
    v_exp_f32 v134, v134
    v_exp_f32 v135, v135
    v_exp_f32 v104, v104
    v_exp_f32 v105, v105
    v_smfmac_f32_32x32x32_bf16 v[152:167], v[52:55], v[128:135], v2
    v_exp_f32 v106, v106
    v_exp_f32 v107, v107
    v_exp_f32 v108, v108
    v_mfma_f32_32x32x16_bf16 v[120:135], v[20:23], v[4:7], 0
    v_exp_f32 v109, v109
    v_exp_f32 v110, v110
    v_exp_f32 v111, v111
    v_exp_f32 v112, v112
    v_exp_f32 v113, v113
    v_exp_f32 v114, v114
    v_smfmac_f32_32x32x32_bf16 v[152:167], v[56:59], v[104:111], v2
    v_exp_f32 v115, v115
    v_exp_f32 v116, v116
    v_exp_f32 v117, v117
    v_exp_f32 v118, v118
    v_exp_f32 v119, v119
    v_exp_f32 v120, v120
    v_exp_f32 v121, v121
    v_smfmac_f32_32x32x32_bf16 v[152:167], v[60:63], v[112:119], v2
    v_exp_f32 v122, v122
    v_exp_f32 v123, v123
    v_exp_f32 v124, v124
    v_mfma_f32_32x32x16_bf16 v[104:119], v[24:27], v[4:7], 0
    v_exp_f32 v125, v125
    v_exp_f32 v126, v126
    v_exp_f32 v127, v127
    v_exp_f32 v128, v128
    v_exp_f32 v129, v129
    v_exp_f32 v130, v130
    v_smfmac_f32_32x32x32_bf16 v[152:167], v[64:67], v[120:127], v2
    v_exp_f32 v131, v131
    v_exp_f32 v132, v132
    v_exp_f32 v133, v133
    v_exp_f32 v134, v134
    v_exp_f32 v135, v135
    v_exp_f32 v104, v104
    v_exp_f32 v105, v105
    v_smfmac_f32_32x32x32_bf16 v[152:167], v[68:71], v[128:135], v2
    v_exp_f32 v106, v106
    v_exp_f32 v107, v107
    v_exp_f32 v108, v108
    v_mfma_f32_32x32x16_bf16 v[120:135], v[28:31], v[4:7], 0
    v_exp_f32 v109, v109
    v_exp_f32 v110, v110
    v_exp_f32 v111, v111
    v_exp_f32 v112, v112
    v_exp_f32 v113, v113
    v_exp_f32 v114, v114
    v_smfmac_f32_32x32x32_bf16 v[152:167], v[72:75], v[104:111], v2
    v_exp_f32 v115, v115
    v_exp_f32 v116, v116
    v_exp_f32 v117, v117
    v_exp_f32 v118, v118
    v_exp_f32 v119, v119
    v_exp_f32 v120, v120
    v_exp_f32 v121, v121
    v_smfmac_f32_32x32x32_bf16 v[152:167], v[76:79], v[112:119], v2
    v_exp_f32 v122, v122
    v_exp_f32 v123, v123
    v_exp_f32 v124, v124
    v_mfma_f32_32x32x16_bf16 v[104:119], v[32:35], v[4:7], 0
    v_exp_f32 v125, v125
    v_exp_f32 v126, v126
    v_exp_f32 v127, v127
    v_exp_f32 v128, v128
    v_exp_f32 v129, v129
    v_exp_f32 v130, v130
    v_smfmac_f32_32x32x32_bf16 v[152:167], v[80:83], v[120:127], v2
    v_exp_f32 v131, v131
    v_exp_f32 v132, v132
    v_exp_f32 v133, v133
    v_exp_f32 v134, v134
    v_exp_f32 v135, v135
    v_exp_f32 v104, v104
    v_exp_f32 v105, v105
    v_smfmac_f32_32x32x32_bf16 v[152:167], v[84:87], v[128:135], v2
    v_exp_f32 v106, v106
    ds_read_b32 v146, v3 offset:61184
    v_exp_f32 v107, v107
    v_exp_f32 v108, v108
    v_mfma_f32_32x32x16_bf16 v[120:135], v[36:39], v[4:7], 0
    v_exp_f32 v109, v109
    v_exp_f32 v110, v110
    v_exp_f32 v111, v111
    v_exp_f32 v112, v112
    v_exp_f32 v113, v113
    v_exp_f32 v114, v114
    v_smfmac_f32_32x32x32_bf16 v[152:167], v[88:91], v[104:111], v2
    v_exp_f32 v115, v115
    v_exp_f32 v116, v116
    s_waitcnt lgkmcnt(0)
    v_cmp_ne_u32 vcc, 1, v146
    s_cbranch_vccnz BP7
BPR7:
    v_exp_f32 v117, v117
    v_exp_f32 v118, v118
    v_exp_f32 v119, v119
    v_exp_f32 v120, v120
    v_exp_f32 v121, v121
    v_smfmac_f32_32x32x32_bf16 v[152:167], v[92:95], v[112:119], v2
    v_exp_f32 v122, v122
    v_exp_f32 v123, v123
    v_exp_f32 v124, v124
    v_exp_f32 v125, v125
    v_exp_f32 v126, v126
    v_exp_f32 v127, v127
    v_exp_f32 v128, v128
    v_exp_f32 v129, v129
    v_exp_f32 v130, v130
    v_smfmac_f32_32x32x32_bf16 v[152:167], v[96:99], v[120:127], v2
    v_exp_f32 v131, v131
    v_exp_f32 v132, v132
    v_exp_f32 v133, v133
    v_exp_f32 v134, v134
    v_exp_f32 v135, v135
    s_nop 1
    v_smfmac_f32_32x32x32_bf16 v[152:167], v[100:103], v[128:135], v2
    s_nop 11
    ds_write_b128 v1, v[152:155] offset:49152
    ds_write_b128 v1, v[156:159] offset:50176
    ds_write_addtid_b32 v160 offset:6144
    s_cmp_lt_u32 s45, 4
    s_cbranch_scc0 NOC7
    ds_add_u32 v3, v2 offset:60160
NOC7:
    s_waitcnt lgkmcnt(0)
    s_barrier
    s_barrier
    ds_read_b32 v4, v3 offset:64256
    s_waitcnt lgkmcnt(0)
    v_cmp_ne_u32 vcc, 0, v4
    s_cbranch_vccnz SLOWA
    s_endpgm
BP4:
    s_add_u32 s67, s67, 1
    s_cmp_gt_u32 s67, 0x100000
    s_cbranch_scc1 END
    s_sleep 4
    ds_read_b32 v146, v3 offset:60416
    s_waitcnt lgkmcnt(0)
    v_cmp_ne_u32 vcc, 1, v146
    s_cbranch_vccnz BP4
    s_branch BPR4
BP5:
    s_add_u32 s67, s67, 1
    s_cmp_gt_u32 s67, 0x100000
    s_cbranch_scc1 END
    s_sleep 4
    ds_read_b32 v162, v3 offset:60672
    s_waitcnt lgkmcnt(0)
    v_cmp_ne_u32 vcc, 1, v162
    s_cbranch_vccnz BP5
    s_branch BPR5
BP6:
    s_add_u32 s67, s67, 1
    s_cmp_gt_u32 s67, 0x100000
    s_cbranch_scc1 END
    s_sleep 4
    ds_read_b32 v146, v3 offset:60928
    s_waitcnt lgkmcnt(0)
    v_cmp_ne_u32 vcc, 1, v146
    s_cbranch_vccnz BP6
    s_branch BPR6
BP7:
    s_add_u32 s67, s67, 1
    s_cmp_gt_u32 s67, 0x100000
    s_cbranch_scc1 END
    s_sleep 4
    ds_read_b32 v146, v3 offset:61184
    s_waitcnt lgkmcnt(0)
    v_cmp_ne_u32 vcc, 1, v146
    s_cbranch_vccnz BP7
    s_branch BPR7
QW:
    s_cmp_lt_u32 s45, 4
    s_cbranch_scc0 QW2
    s_waitcnt vmcnt(0)
    ds_add_u32 v3, v2 offset:63232
QW2:
    ds_read_b32 v162, v3 offset:63232
    ds_read_b128 v[4:7], v0 offset:13312
    s_waitcnt lgkmcnt(1)
    v_cmp_ne_u32 vcc, 0x37778, v162
    s_cbranch_vccz QWRET
    s_add_u32 s67, s67, 1
    s_cmp_gt_u32 s67, 0x100000
    s_cbranch_scc1 END
    s_sleep 1
    s_branch QW2
GEMM:
    v_lshlrev_b32 v28, 4, v0
    v_mov_b32 v32, 0
    v_mov_b32 v33, 0
    v_mov_b32 v34, 0
    v_mov_b32 v35, 0
    ds_write_b128 v28, v[32:35] offset:58368
    ds_write_b128 v28, v[32:35] offset:61440
    v_lshlrev_b32 v24, 2, v1
    v_mov_b32 v25, 0
    s_lshl_b32 s3, s3, 6
    v_add_u32 v22, s3, v1
    s_movk_i32 s60, 3072
    v_mul_u32_u24 v22, s60, v22
    s_lshl_b32 s62, s47, 7
    s_lshl_b32 s63, s44, 10
    s_add_u32 s62, s62, s63
    s_waitcnt lgkmcnt(0)
    s_mov_b64 s[28:29], s[26:27]
    s_mov_b32 s3, 0x47c000
    buffer_load_dword v25, v25, s[28:31], s3 offen sc1
    s_mov_b64 s[36:37], s[6:7]
    s_mov_b32 s38, 0x180000
    s_mov_b32 s39, 0x20000
    s_cmp_eq_u32 s44, 3
    s_cbranch_scc1 NOTCH
NOTCH:
    s_getpc_b64 s[62:63]
PC0:
    s_sub_u32 s62, s62, PC0-gated_mix__linear_attn_block__grouped_kv_mqa__prompt_kernel
    s_subb_u32 s63, s63, 0
    s_bfe_u32 s3, s2, 0x30003
    s_lshl_b32 s3, s3, 12
    v_add_u32 v22, s3, v28
    global_load_dwordx4 v[128:131], v22, s[62:63]
    v_and_b32 v20, 31, v1
    v_lshrrev_b32 v21, 5, v1
    v_bfe_u32 v22, v1, 1, 3
    v_xor_b32 v22, v22, v21
    v_lshlrev_b32 v22, 4, v22
    v_lshl_add_u32 v22, v20, 7, v22
    s_lshr_b32 s3, s44, 1
    s_lshl_b32 s3, s3, 12
    s_add_u32 s3, s3, 0x10000
    v_add_u32 v2, s3, v22
    v_xor_b32 v3, 32, v2
    v_xor_b32 v4, 64, v2
    v_xor_b32 v5, 96, v2
    v_bfe_u32 v22, v1, 2, 2
    v_lshl_add_u32 v23, v21, 3, v22
    v_lshlrev_b32 v23, 7, v23
    v_bfe_u32 v26, v1, 4, 1
    v_lshlrev_b32 v26, 1, v26
    v_bfe_u32 v27, v1, 1, 1
    v_or_b32 v26, v26, v27
    s_and_b32 s3, s44, 1
    s_lshl_b32 s3, s3, 2
    v_or_b32 v26, s3, v26
    v_bfe_u32 v27, v1, 3, 1
    v_lshlrev_b32 v27, 2, v27
    v_xor_b32 v26, v26, v27
    v_lshl_add_u32 v23, v26, 4, v23
    v_and_b32 v27, 1, v1
    v_lshl_add_u32 v10, v27, 3, v23
    v_add_u32 v11, 0x20000, v10
    s_mov_b32 s58, 0x3fb8aa3b
    s_mov_b32 s59, 0x3fb8aa3b
    s_mov_b32 s60, 0x358637bd
    s_mov_b32 s61, 0x358637bd
    s_lshl_b32 s3, s46, 1
    s_lshr_b32 s62, s44, 1
    s_add_u32 s3, s3, s62
    s_lshl_b32 s3, s3, 5
    s_lshl_b32 s62, s47, 2
    s_add_u32 s3, s3, s62
    s_and_b32 s62, s44, 1
    s_lshl_b32 s62, s62, 1
    s_add_u32 s3, s3, s62
    s_lshl_b32 s3, s3, 10
    s_xor_b32 s16, s3, 8192
    v_lshl_add_u32 v26, v1, 4, s16
    s_xor_b32 s16, s3, 4096
    s_add_u32 s16, s16, 0x200000
    s_lshl_b32 s18, s46, 8
    s_lshr_b32 s3, s44, 1
    s_lshl_b32 s3, s3, 7
    s_add_u32 s18, s18, s3
    s_add_u32 s18, s18, 0x420000
    s_mul_i32 s64, s46, 34816
    s_lshl_b32 s3, s47, 1
    s_and_b32 s62, s44, 1
    s_add_u32 s3, s3, s62
    s_xor_b32 s17, s3, 2
    s_mul_i32 s17, s17, 1088
    s_add_u32 s17, s17, 0x430000
    s_mul_i32 s3, s3, 2176
    s_add_u32 s64, s64, s3
    s_add_u32 s64, s64, 0x600000
    s_lshl_b32 s65, s46, 10
    s_lshl_b32 s3, s47, 7
    s_add_u32 s65, s65, s3
    s_add_u32 s65, s65, 0x4b0000
    s_lshl_b32 s66, s47, 12
    s_lshl_b32 s3, s46, 7
    s_add_u32 s66, s66, s3
    s_add_u32 s66, s66, 0x4b8000
    s_lshl_b32 s50, s47, 1
    s_add_u32 s50, s50, s62
    s_lshl_b32 s50, s50, 12
    s_add_u32 s50, s50, s3
    s_add_u32 s50, s50, 0x4c0000
    v_mov_b32 v28, 0x3f803f80
    v_mov_b32 v29, 0x3f803f80
    v_mov_b32 v30, 0x3f803f80
    v_mov_b32 v31, 0x3f803f80
    v_mov_b32 v23, 1
    v_lshlrev_b32 v27, 4, v1
    s_lshl_b32 s3, s62, 12
    v_add_u32 v12, s3, v27
    s_lshl_b32 s3, s62, 7
    v_lshl_add_u32 v13, v20, 2, s3
    v_lshl_add_u32 v14, v21, 2, v20
    v_lshlrev_b32 v14, 4, v14
    s_cmp_eq_u32 s44, 0
    s_cbranch_scc0 NOTW
    s_and_b32 s3, s2, 7
    s_lshl_b32 s3, s3, 5
    s_lshr_b32 s10, s2, 3
    s_add_u32 s3, s3, s10
    s_lshl_b32 s10, s3, 13
    s_add_u32 s10, s10, 0x800000
    s_lshl_b32 s3, s3, 13
    s_mov_b64 s[32:33], s[22:23]
    s_mov_b32 s34, 0x200000
    s_mov_b32 s35, 0x20000
    s_mov_b64 exec, 1
    buffer_load_dword v132, v26, s[28:31], 0 offen sc1
    buffer_load_dword v133, v27, s[28:31], s16 offen sc1
    buffer_load_dword v134, v27, s[28:31], s64 offen sc1
    buffer_load_dword v135, v27, s[28:31], s10 offen sc1
    buffer_load_dword v15, v27, s[32:35], s3 offen sc1
    s_mov_b64 exec, -1
NOTW:
    s_barrier
    ds_read_b128 v[136:139], v2 offset:0
    ds_read_b64_tr_b16 v[140:141], v10 offset:0
    ds_read_b64_tr_b16 v[142:143], v10 offset:512
    ds_read_b128 v[144:147], v3 offset:0
    ds_read_b64_tr_b16 v[148:149], v10 offset:2048
    ds_read_b64_tr_b16 v[150:151], v10 offset:2560
    ds_read_b128 v[152:155], v4 offset:0
    ds_read_b64_tr_b16 v[156:157], v10 offset:4096
    ds_read_b64_tr_b16 v[158:159], v10 offset:4608
    s_waitcnt lgkmcnt(6)
    v_mfma_f32_32x32x16_bf16 v[64:79], v[140:143], v[136:139], 0
    ds_read_b128 v[160:163], v5 offset:0
    ds_read_b64_tr_b16 v[164:165], v10 offset:6144
    ds_read_b64_tr_b16 v[166:167], v10 offset:6656
    s_waitcnt lgkmcnt(6)
    v_mfma_f32_32x32x16_bf16 v[64:79], v[148:151], v[144:147], v[64:79]
    ds_read_b128 v[136:139], v2 offset:8192
    ds_read_b64_tr_b16 v[140:141], v10 offset:8192
    ds_read_b64_tr_b16 v[142:143], v10 offset:8704
    s_waitcnt lgkmcnt(6)
    v_mfma_f32_32x32x16_bf16 v[64:79], v[156:159], v[152:155], v[64:79]
    ds_read_b128 v[144:147], v3 offset:8192
    ds_read_b64_tr_b16 v[148:149], v10 offset:10240
    ds_read_b64_tr_b16 v[150:151], v10 offset:10752
    s_waitcnt lgkmcnt(6)
    v_mfma_f32_32x32x16_bf16 v[64:79], v[164:167], v[160:163], v[64:79]
    ds_read_b128 v[152:155], v4 offset:8192
    ds_read_b64_tr_b16 v[156:157], v10 offset:12288
    ds_read_b64_tr_b16 v[158:159], v10 offset:12800
    s_waitcnt lgkmcnt(6)
    v_mfma_f32_32x32x16_bf16 v[64:79], v[140:143], v[136:139], v[64:79]
    ds_read_b128 v[160:163], v5 offset:8192
    ds_read_b64_tr_b16 v[164:165], v10 offset:14336
    ds_read_b64_tr_b16 v[166:167], v10 offset:14848
    s_waitcnt lgkmcnt(6)
    v_mfma_f32_32x32x16_bf16 v[64:79], v[148:151], v[144:147], v[64:79]
    s_waitcnt lgkmcnt(3)
    v_mfma_f32_32x32x16_bf16 v[64:79], v[156:159], v[152:155], v[64:79]
    s_waitcnt lgkmcnt(0)
    s_waitcnt vmcnt(0)
    v_add_u32 v25, 0x9e3779b1, v25
    s_barrier
    v_mfma_f32_32x32x16_bf16 v[64:79], v[164:167], v[160:163], v[64:79]
    ds_read_b128 v[32:35], v2 offset:0
    ds_read_b64_tr_b16 v[36:37], v10 offset:24576
    ds_read_b64_tr_b16 v[38:39], v10 offset:25088
    ds_read_b64_tr_b16 v[40:41], v10 offset:32768
    ds_read_b64_tr_b16 v[42:43], v10 offset:33280
    ds_read_b64_tr_b16 v[44:45], v10 offset:40960
    ds_read_b64_tr_b16 v[46:47], v10 offset:41472
    s_waitcnt lgkmcnt(4)
    v_mfma_f32_32x32x16_bf16 v[80:95], v[36:39], v[32:35], 1.0
    ds_read_b128 v[48:51], v3 offset:0
    ds_read_b64_tr_b16 v[52:53], v10 offset:26624
    ds_read_b64_tr_b16 v[54:55], v10 offset:27136
    s_waitcnt lgkmcnt(5)
    v_mfma_f32_32x32x16_bf16 v[96:111], v[32:35], v[40:43], 1.0
    ds_read_b64_tr_b16 v[56:57], v10 offset:34816
    ds_read_b64_tr_b16 v[58:59], v10 offset:35328
    s_waitcnt lgkmcnt(5)
    v_mfma_f32_32x32x16_bf16 v[112:127], v[32:35], v[44:47], 0
    ds_read_b64_tr_b16 v[60:61], v10 offset:43008
    ds_read_b64_tr_b16 v[62:63], v10 offset:43520
    s_waitcnt lgkmcnt(4)
    v_mfma_f32_32x32x16_bf16 v[80:95], v[52:55], v[48:51], v[80:95]
    ds_read_b128 v[32:35], v4 offset:0
    ds_read_b64_tr_b16 v[36:37], v10 offset:28672
    ds_read_b64_tr_b16 v[38:39], v10 offset:29184
    s_waitcnt lgkmcnt(5)
    v_mfma_f32_32x32x16_bf16 v[96:111], v[48:51], v[56:59], v[96:111]
    ds_read_b64_tr_b16 v[40:41], v10 offset:36864
    ds_read_b64_tr_b16 v[42:43], v10 offset:37376
    s_waitcnt lgkmcnt(5)
    v_mfma_f32_32x32x16_bf16 v[112:127], v[48:51], v[60:63], v[112:127]
    ds_read_b64_tr_b16 v[44:45], v10 offset:45056
    ds_read_b64_tr_b16 v[46:47], v10 offset:45568
    s_waitcnt lgkmcnt(4)
    v_mfma_f32_32x32x16_bf16 v[80:95], v[36:39], v[32:35], v[80:95]
    ds_read_b128 v[48:51], v5 offset:0
    ds_read_b64_tr_b16 v[52:53], v10 offset:30720
    ds_read_b64_tr_b16 v[54:55], v10 offset:31232
    s_waitcnt lgkmcnt(5)
    v_mfma_f32_32x32x16_bf16 v[96:111], v[32:35], v[40:43], v[96:111]
    ds_read_b64_tr_b16 v[56:57], v10 offset:38912
    ds_read_b64_tr_b16 v[58:59], v10 offset:39424
    s_waitcnt lgkmcnt(5)
    v_mfma_f32_32x32x16_bf16 v[112:127], v[32:35], v[44:47], v[112:127]
    ds_read_b64_tr_b16 v[60:61], v10 offset:47104
    ds_read_b64_tr_b16 v[62:63], v10 offset:47616
    s_waitcnt lgkmcnt(4)
    v_mfma_f32_32x32x16_bf16 v[80:95], v[52:55], v[48:51], v[80:95]
    s_waitcnt lgkmcnt(0)
    s_barrier
    ds_read_b128 v[136:139], v2 offset:16384
    ds_read_b64_tr_b16 v[140:141], v11 offset:0
    ds_read_b64_tr_b16 v[142:143], v11 offset:512
    v_mfma_f32_32x32x16_bf16 v[96:111], v[48:51], v[56:59], v[96:111]
    ds_read_b128 v[144:147], v3 offset:16384
    ds_read_b64_tr_b16 v[148:149], v11 offset:2048
    ds_read_b64_tr_b16 v[150:151], v11 offset:2560
    v_mfma_f32_32x32x16_bf16 v[112:127], v[48:51], v[60:63], v[112:127]
    ds_read_b128 v[152:155], v4 offset:16384
    ds_read_b64_tr_b16 v[156:157], v11 offset:4096
    ds_read_b64_tr_b16 v[158:159], v11 offset:4608
    s_waitcnt lgkmcnt(6)
    v_mfma_f32_32x32x16_bf16 v[64:79], v[140:143], v[136:139], v[64:79]
    ds_read_b128 v[160:163], v5 offset:16384
    ds_read_b64_tr_b16 v[164:165], v11 offset:6144
    ds_read_b64_tr_b16 v[166:167], v11 offset:6656
    s_waitcnt lgkmcnt(6)
    v_mfma_f32_32x32x16_bf16 v[64:79], v[148:151], v[144:147], v[64:79]
    ds_read_b128 v[136:139], v2 offset:24576
    ds_read_b64_tr_b16 v[140:141], v11 offset:8192
    ds_read_b64_tr_b16 v[142:143], v11 offset:8704
    s_waitcnt lgkmcnt(6)
    v_mfma_f32_32x32x16_bf16 v[64:79], v[156:159], v[152:155], v[64:79]
    ds_read_b128 v[144:147], v3 offset:24576
    ds_read_b64_tr_b16 v[148:149], v11 offset:10240
    ds_read_b64_tr_b16 v[150:151], v11 offset:10752
    s_waitcnt lgkmcnt(6)
    v_mfma_f32_32x32x16_bf16 v[64:79], v[164:167], v[160:163], v[64:79]
    ds_read_b128 v[152:155], v4 offset:24576
    ds_read_b64_tr_b16 v[156:157], v11 offset:12288
    ds_read_b64_tr_b16 v[158:159], v11 offset:12800
    s_waitcnt lgkmcnt(6)
    v_mfma_f32_32x32x16_bf16 v[64:79], v[140:143], v[136:139], v[64:79]
    ds_read_b128 v[160:163], v5 offset:24576
    ds_read_b64_tr_b16 v[164:165], v11 offset:14336
    ds_read_b64_tr_b16 v[166:167], v11 offset:14848
    s_waitcnt lgkmcnt(6)
    v_mfma_f32_32x32x16_bf16 v[64:79], v[148:151], v[144:147], v[64:79]
    s_waitcnt lgkmcnt(3)
    v_mfma_f32_32x32x16_bf16 v[64:79], v[156:159], v[152:155], v[64:79]
    s_waitcnt lgkmcnt(0)
    s_barrier
    v_mfma_f32_32x32x16_bf16 v[64:79], v[164:167], v[160:163], v[64:79]
    ds_read_b128 v[136:139], v2 offset:32768
    ds_read_b64_tr_b16 v[140:141], v10 offset:0
    ds_read_b64_tr_b16 v[142:143], v10 offset:512
    ds_read_b128 v[144:147], v3 offset:32768
    ds_read_b64_tr_b16 v[148:149], v10 offset:2048
    ds_read_b64_tr_b16 v[150:151], v10 offset:2560
    ds_read_b128 v[152:155], v4 offset:32768
    ds_read_b64_tr_b16 v[156:157], v10 offset:4096
    ds_read_b64_tr_b16 v[158:159], v10 offset:4608
    s_waitcnt lgkmcnt(6)
    v_mfma_f32_32x32x16_bf16 v[64:79], v[140:143], v[136:139], v[64:79]
    ds_read_b128 v[160:163], v5 offset:32768
    ds_read_b64_tr_b16 v[164:165], v10 offset:6144
    ds_read_b64_tr_b16 v[166:167], v10 offset:6656
    s_waitcnt lgkmcnt(6)
    v_mfma_f32_32x32x16_bf16 v[64:79], v[148:151], v[144:147], v[64:79]
    ds_read_b128 v[136:139], v2 offset:40960
    ds_read_b64_tr_b16 v[140:141], v10 offset:8192
    ds_read_b64_tr_b16 v[142:143], v10 offset:8704
    s_waitcnt lgkmcnt(6)
    v_mfma_f32_32x32x16_bf16 v[64:79], v[156:159], v[152:155], v[64:79]
    ds_read_b128 v[144:147], v3 offset:40960
    ds_read_b64_tr_b16 v[148:149], v10 offset:10240
    ds_read_b64_tr_b16 v[150:151], v10 offset:10752
    s_waitcnt lgkmcnt(6)
    v_mfma_f32_32x32x16_bf16 v[64:79], v[164:167], v[160:163], v[64:79]
    ds_read_b128 v[152:155], v4 offset:40960
    ds_read_b64_tr_b16 v[156:157], v10 offset:12288
    ds_read_b64_tr_b16 v[158:159], v10 offset:12800
    s_waitcnt lgkmcnt(6)
    v_mfma_f32_32x32x16_bf16 v[64:79], v[140:143], v[136:139], v[64:79]
    ds_read_b128 v[160:163], v5 offset:40960
    ds_read_b64_tr_b16 v[164:165], v10 offset:14336
    ds_read_b64_tr_b16 v[166:167], v10 offset:14848
    s_waitcnt lgkmcnt(6)
    v_mfma_f32_32x32x16_bf16 v[64:79], v[148:151], v[144:147], v[64:79]
    s_waitcnt lgkmcnt(3)
    v_mfma_f32_32x32x16_bf16 v[64:79], v[156:159], v[152:155], v[64:79]
    s_waitcnt lgkmcnt(0)
    s_barrier
    v_mfma_f32_32x32x16_bf16 v[64:79], v[164:167], v[160:163], v[64:79]
    ds_read_b128 v[136:139], v2 offset:49152
    ds_read_b64_tr_b16 v[140:141], v10 offset:24576
    ds_read_b64_tr_b16 v[142:143], v10 offset:25088
    ds_read_b128 v[144:147], v3 offset:49152
    ds_read_b64_tr_b16 v[148:149], v10 offset:26624
    ds_read_b64_tr_b16 v[150:151], v10 offset:27136
    ds_read_b128 v[152:155], v4 offset:49152
    ds_read_b64_tr_b16 v[156:157], v10 offset:28672
    ds_read_b64_tr_b16 v[158:159], v10 offset:29184
    s_waitcnt lgkmcnt(6)
    v_mfma_f32_32x32x16_bf16 v[64:79], v[140:143], v[136:139], v[64:79]
    ds_read_b128 v[160:163], v5 offset:49152
    ds_read_b64_tr_b16 v[164:165], v10 offset:30720
    ds_read_b64_tr_b16 v[166:167], v10 offset:31232
    s_waitcnt lgkmcnt(6)
    v_mfma_f32_32x32x16_bf16 v[64:79], v[148:151], v[144:147], v[64:79]
    ds_read_b128 v[136:139], v2 offset:57344
    ds_read_b64_tr_b16 v[140:141], v10 offset:32768
    ds_read_b64_tr_b16 v[142:143], v10 offset:33280
    s_waitcnt lgkmcnt(6)
    v_mfma_f32_32x32x16_bf16 v[64:79], v[156:159], v[152:155], v[64:79]
    ds_read_b128 v[144:147], v3 offset:57344
    ds_read_b64_tr_b16 v[148:149], v10 offset:34816
    ds_read_b64_tr_b16 v[150:151], v10 offset:35328
    s_waitcnt lgkmcnt(6)
    v_mfma_f32_32x32x16_bf16 v[64:79], v[164:167], v[160:163], v[64:79]
    ds_read_b128 v[152:155], v4 offset:57344
    ds_read_b64_tr_b16 v[156:157], v10 offset:36864
    ds_read_b64_tr_b16 v[158:159], v10 offset:37376
    s_waitcnt lgkmcnt(6)
    v_mfma_f32_32x32x16_bf16 v[64:79], v[140:143], v[136:139], v[64:79]
    ds_read_b128 v[160:163], v5 offset:57344
    ds_read_b64_tr_b16 v[164:165], v10 offset:38912
    ds_read_b64_tr_b16 v[166:167], v10 offset:39424
    s_waitcnt lgkmcnt(6)
    v_mfma_f32_32x32x16_bf16 v[64:79], v[148:151], v[144:147], v[64:79]
    s_waitcnt lgkmcnt(3)
    v_mfma_f32_32x32x16_bf16 v[64:79], v[156:159], v[152:155], v[64:79]
    s_waitcnt lgkmcnt(0)
    s_barrier
    v_mfma_f32_32x32x16_bf16 v[64:79], v[164:167], v[160:163], v[64:79]
    ds_read_b128 v[32:35], v2 offset:8192
    ds_read_b64_tr_b16 v[36:37], v11 offset:0
    ds_read_b64_tr_b16 v[38:39], v11 offset:512
    ds_read_b64_tr_b16 v[40:41], v11 offset:8192
    ds_read_b64_tr_b16 v[42:43], v11 offset:8704
    ds_read_b64_tr_b16 v[44:45], v11 offset:16384
    ds_read_b64_tr_b16 v[46:47], v11 offset:16896
    s_waitcnt lgkmcnt(4)
    v_mfma_f32_32x32x16_bf16 v[80:95], v[36:39], v[32:35], v[80:95]
    s_nop 2
    v_cvt_pk_bf16_f32 v136, v64, v65
    v_cvt_pk_bf16_f32 v137, v66, v67
    v_cvt_pk_bf16_f32 v138, v68, v69
    v_cvt_pk_bf16_f32 v139, v70, v71
    buffer_store_dwordx4 v[136:139], v26, s[28:31], 0 offen sc1
    ds_read_b128 v[48:51], v3 offset:8192
    ds_read_b64_tr_b16 v[52:53], v11 offset:2048
    ds_read_b64_tr_b16 v[54:55], v11 offset:2560
    s_waitcnt lgkmcnt(5)
    v_mfma_f32_32x32x16_bf16 v[96:111], v[32:35], v[40:43], v[96:111]
    ds_read_b64_tr_b16 v[56:57], v11 offset:10240
    ds_read_b64_tr_b16 v[58:59], v11 offset:10752
    s_waitcnt lgkmcnt(5)
    v_mfma_f32_32x32x16_bf16 v[112:127], v[32:35], v[44:47], v[112:127]
    ds_read_b64_tr_b16 v[60:61], v11 offset:18432
    ds_read_b64_tr_b16 v[62:63], v11 offset:18944
    s_waitcnt lgkmcnt(4)
    v_mfma_f32_32x32x16_bf16 v[80:95], v[52:55], v[48:51], v[80:95]
    v_cvt_pk_bf16_f32 v140, v72, v73
    v_cvt_pk_bf16_f32 v141, v74, v75
    v_cvt_pk_bf16_f32 v142, v76, v77
    v_cvt_pk_bf16_f32 v143, v78, v79
    buffer_store_dwordx4 v[140:143], v26, s[28:31], 0 offen offset:1024 sc1
    ds_read_b128 v[32:35], v4 offset:8192
    ds_read_b64_tr_b16 v[36:37], v11 offset:4096
    ds_read_b64_tr_b16 v[38:39], v11 offset:4608
    s_waitcnt lgkmcnt(5)
    v_mfma_f32_32x32x16_bf16 v[96:111], v[48:51], v[56:59], v[96:111]
    ds_read_b64_tr_b16 v[40:41], v11 offset:12288
    ds_read_b64_tr_b16 v[42:43], v11 offset:12800
    s_waitcnt lgkmcnt(5)
    v_mfma_f32_32x32x16_bf16 v[112:127], v[48:51], v[60:63], v[112:127]
    ds_read_b64_tr_b16 v[44:45], v11 offset:20480
    ds_read_b64_tr_b16 v[46:47], v11 offset:20992
    s_waitcnt lgkmcnt(4)
    v_mfma_f32_32x32x16_bf16 v[80:95], v[36:39], v[32:35], v[80:95]
    ds_read_b128 v[48:51], v5 offset:8192
    ds_read_b64_tr_b16 v[52:53], v11 offset:6144
    ds_read_b64_tr_b16 v[54:55], v11 offset:6656
    s_waitcnt lgkmcnt(5)
    v_mfma_f32_32x32x16_bf16 v[96:111], v[32:35], v[40:43], v[96:111]
    ds_read_b64_tr_b16 v[56:57], v11 offset:14336
    ds_read_b64_tr_b16 v[58:59], v11 offset:14848
    s_waitcnt lgkmcnt(5)
    v_mfma_f32_32x32x16_bf16 v[112:127], v[32:35], v[44:47], v[112:127]
    ds_read_b64_tr_b16 v[60:61], v11 offset:22528
    ds_read_b64_tr_b16 v[62:63], v11 offset:23040
    s_waitcnt lgkmcnt(4)
    v_mfma_f32_32x32x16_bf16 v[80:95], v[52:55], v[48:51], v[80:95]
    s_waitcnt lgkmcnt(0)
    s_barrier
    ds_read_b128 v[32:35], v2 offset:16384
    ds_read_b64_tr_b16 v[36:37], v10 offset:0
    ds_read_b64_tr_b16 v[38:39], v10 offset:512
    v_mfma_f32_32x32x16_bf16 v[96:111], v[48:51], v[56:59], v[96:111]
    ds_read_b64_tr_b16 v[40:41], v10 offset:8192
    ds_read_b64_tr_b16 v[42:43], v10 offset:8704
    v_mfma_f32_32x32x16_bf16 v[112:127], v[48:51], v[60:63], v[112:127]
    ds_read_b64_tr_b16 v[44:45], v10 offset:16384
    ds_read_b64_tr_b16 v[46:47], v10 offset:16896
    s_waitcnt lgkmcnt(4)
    v_mfma_f32_32x32x16_bf16 v[80:95], v[36:39], v[32:35], v[80:95]
    ds_read_b128 v[48:51], v3 offset:16384
    ds_read_b64_tr_b16 v[52:53], v10 offset:2048
    ds_read_b64_tr_b16 v[54:55], v10 offset:2560
    s_waitcnt lgkmcnt(5)
    v_mfma_f32_32x32x16_bf16 v[96:111], v[32:35], v[40:43], v[96:111]
    ds_read_b64_tr_b16 v[56:57], v10 offset:10240
    ds_read_b64_tr_b16 v[58:59], v10 offset:10752
    s_waitcnt lgkmcnt(5)
    v_mfma_f32_32x32x16_bf16 v[112:127], v[32:35], v[44:47], v[112:127]
    ds_read_b64_tr_b16 v[60:61], v10 offset:18432
    ds_read_b64_tr_b16 v[62:63], v10 offset:18944
    s_waitcnt lgkmcnt(4)
    v_mfma_f32_32x32x16_bf16 v[80:95], v[52:55], v[48:51], v[80:95]
    ds_read_b128 v[32:35], v4 offset:16384
    ds_read_b64_tr_b16 v[36:37], v10 offset:4096
    ds_read_b64_tr_b16 v[38:39], v10 offset:4608
    s_waitcnt lgkmcnt(5)
    v_mfma_f32_32x32x16_bf16 v[96:111], v[48:51], v[56:59], v[96:111]
    ds_read_b64_tr_b16 v[40:41], v10 offset:12288
    ds_read_b64_tr_b16 v[42:43], v10 offset:12800
    s_waitcnt lgkmcnt(5)
    v_mfma_f32_32x32x16_bf16 v[112:127], v[48:51], v[60:63], v[112:127]
    ds_read_b64_tr_b16 v[44:45], v10 offset:20480
    ds_read_b64_tr_b16 v[46:47], v10 offset:20992
    s_waitcnt lgkmcnt(4)
    v_mfma_f32_32x32x16_bf16 v[80:95], v[36:39], v[32:35], v[80:95]
    ds_read_b128 v[48:51], v5 offset:16384
    ds_read_b64_tr_b16 v[52:53], v10 offset:6144
    ds_read_b64_tr_b16 v[54:55], v10 offset:6656
    s_waitcnt lgkmcnt(5)
    v_mfma_f32_32x32x16_bf16 v[96:111], v[32:35], v[40:43], v[96:111]
    ds_read_b64_tr_b16 v[56:57], v10 offset:14336
    ds_read_b64_tr_b16 v[58:59], v10 offset:14848
    s_waitcnt lgkmcnt(5)
    v_mfma_f32_32x32x16_bf16 v[112:127], v[32:35], v[44:47], v[112:127]
    ds_read_b64_tr_b16 v[60:61], v10 offset:22528
    ds_read_b64_tr_b16 v[62:63], v10 offset:23040
    s_waitcnt lgkmcnt(4)
    v_mfma_f32_32x32x16_bf16 v[80:95], v[52:55], v[48:51], v[80:95]
    s_waitcnt lgkmcnt(0)
    s_waitcnt vmcnt(0)
    s_barrier
    s_cmp_eq_u32 s44, 0
    s_cbranch_scc0 NOEF
    s_mov_b32 exec_hi, 0
    buffer_store_dword v25, v24, s[28:31], s65 offen sc1
    s_mov_b64 exec, -1
NOEF:
    ds_read_b128 v[32:35], v2 offset:24576
    ds_read_b64_tr_b16 v[36:37], v10 offset:24576
    ds_read_b64_tr_b16 v[38:39], v10 offset:25088
    v_mfma_f32_32x32x16_bf16 v[96:111], v[48:51], v[56:59], v[96:111]
    ds_read_b64_tr_b16 v[40:41], v10 offset:32768
    ds_read_b64_tr_b16 v[42:43], v10 offset:33280
    v_mfma_f32_32x32x16_bf16 v[112:127], v[48:51], v[60:63], v[112:127]
    ds_read_b64_tr_b16 v[44:45], v10 offset:40960
    ds_read_b64_tr_b16 v[46:47], v10 offset:41472
    s_waitcnt lgkmcnt(4)
    v_mfma_f32_32x32x16_bf16 v[80:95], v[36:39], v[32:35], v[80:95]
    ds_read_b128 v[48:51], v3 offset:24576
    ds_read_b64_tr_b16 v[52:53], v10 offset:26624
    ds_read_b64_tr_b16 v[54:55], v10 offset:27136
    s_waitcnt lgkmcnt(5)
    v_mfma_f32_32x32x16_bf16 v[96:111], v[32:35], v[40:43], v[96:111]
    ds_read_b64_tr_b16 v[56:57], v10 offset:34816
    ds_read_b64_tr_b16 v[58:59], v10 offset:35328
    s_waitcnt lgkmcnt(5)
    v_mfma_f32_32x32x16_bf16 v[112:127], v[32:35], v[44:47], v[112:127]
    ds_read_b64_tr_b16 v[60:61], v10 offset:43008
    ds_read_b64_tr_b16 v[62:63], v10 offset:43520
    s_waitcnt lgkmcnt(4)
    v_mfma_f32_32x32x16_bf16 v[80:95], v[52:55], v[48:51], v[80:95]
    ds_read_b128 v[32:35], v4 offset:24576
    ds_read_b64_tr_b16 v[36:37], v10 offset:28672
    ds_read_b64_tr_b16 v[38:39], v10 offset:29184
    s_waitcnt lgkmcnt(5)
    v_mfma_f32_32x32x16_bf16 v[96:111], v[48:51], v[56:59], v[96:111]
    ds_read_b64_tr_b16 v[40:41], v10 offset:36864
    ds_read_b64_tr_b16 v[42:43], v10 offset:37376
    s_waitcnt lgkmcnt(5)
    v_mfma_f32_32x32x16_bf16 v[112:127], v[48:51], v[60:63], v[112:127]
    ds_read_b64_tr_b16 v[44:45], v10 offset:45056
    ds_read_b64_tr_b16 v[46:47], v10 offset:45568
    s_waitcnt lgkmcnt(4)
    v_mfma_f32_32x32x16_bf16 v[80:95], v[36:39], v[32:35], v[80:95]
    ds_read_b128 v[48:51], v5 offset:24576
    ds_read_b64_tr_b16 v[52:53], v10 offset:30720
    ds_read_b64_tr_b16 v[54:55], v10 offset:31232
    s_waitcnt lgkmcnt(5)
    v_mfma_f32_32x32x16_bf16 v[96:111], v[32:35], v[40:43], v[96:111]
    ds_read_b64_tr_b16 v[56:57], v10 offset:38912
    ds_read_b64_tr_b16 v[58:59], v10 offset:39424
    s_waitcnt lgkmcnt(5)
    v_mfma_f32_32x32x16_bf16 v[112:127], v[32:35], v[44:47], v[112:127]
    ds_read_b64_tr_b16 v[60:61], v10 offset:47104
    ds_read_b64_tr_b16 v[62:63], v10 offset:47616
    s_waitcnt lgkmcnt(4)
    v_mfma_f32_32x32x16_bf16 v[80:95], v[52:55], v[48:51], v[80:95]
    s_waitcnt lgkmcnt(0)
    s_barrier
    ds_read_b128 v[32:35], v2 offset:32768
    ds_read_b64_tr_b16 v[36:37], v11 offset:0
    ds_read_b64_tr_b16 v[38:39], v11 offset:512
    v_mfma_f32_32x32x16_bf16 v[96:111], v[48:51], v[56:59], v[96:111]
    ds_read_b64_tr_b16 v[40:41], v11 offset:8192
    ds_read_b64_tr_b16 v[42:43], v11 offset:8704
    v_mfma_f32_32x32x16_bf16 v[112:127], v[48:51], v[60:63], v[112:127]
    ds_read_b64_tr_b16 v[44:45], v11 offset:16384
    ds_read_b64_tr_b16 v[46:47], v11 offset:16896
    s_waitcnt lgkmcnt(4)
    v_mfma_f32_32x32x16_bf16 v[80:95], v[36:39], v[32:35], v[80:95]
    ds_read_b128 v[48:51], v3 offset:32768
    ds_read_b64_tr_b16 v[52:53], v11 offset:2048
    ds_read_b64_tr_b16 v[54:55], v11 offset:2560
    s_waitcnt lgkmcnt(5)
    v_mfma_f32_32x32x16_bf16 v[96:111], v[32:35], v[40:43], v[96:111]
    ds_read_b64_tr_b16 v[56:57], v11 offset:10240
    ds_read_b64_tr_b16 v[58:59], v11 offset:10752
    s_waitcnt lgkmcnt(5)
    v_mfma_f32_32x32x16_bf16 v[112:127], v[32:35], v[44:47], v[112:127]
    ds_read_b64_tr_b16 v[60:61], v11 offset:18432
    ds_read_b64_tr_b16 v[62:63], v11 offset:18944
    s_waitcnt lgkmcnt(4)
    v_mfma_f32_32x32x16_bf16 v[80:95], v[52:55], v[48:51], v[80:95]
    ds_read_b128 v[32:35], v4 offset:32768
    ds_read_b64_tr_b16 v[36:37], v11 offset:4096
    ds_read_b64_tr_b16 v[38:39], v11 offset:4608
    s_waitcnt lgkmcnt(5)
    v_mfma_f32_32x32x16_bf16 v[96:111], v[48:51], v[56:59], v[96:111]
    ds_read_b64_tr_b16 v[40:41], v11 offset:12288
    ds_read_b64_tr_b16 v[42:43], v11 offset:12800
    s_waitcnt lgkmcnt(5)
    v_mfma_f32_32x32x16_bf16 v[112:127], v[48:51], v[60:63], v[112:127]
    ds_read_b64_tr_b16 v[44:45], v11 offset:20480
    ds_read_b64_tr_b16 v[46:47], v11 offset:20992
    s_waitcnt lgkmcnt(4)
    v_mfma_f32_32x32x16_bf16 v[80:95], v[36:39], v[32:35], v[80:95]
    ds_read_b128 v[48:51], v5 offset:32768
    ds_read_b64_tr_b16 v[52:53], v11 offset:6144
    ds_read_b64_tr_b16 v[54:55], v11 offset:6656
    s_waitcnt lgkmcnt(5)
    v_mfma_f32_32x32x16_bf16 v[96:111], v[32:35], v[40:43], v[96:111]
    ds_read_b64_tr_b16 v[56:57], v11 offset:14336
    ds_read_b64_tr_b16 v[58:59], v11 offset:14848
    s_waitcnt lgkmcnt(5)
    v_mfma_f32_32x32x16_bf16 v[112:127], v[32:35], v[44:47], v[112:127]
    ds_read_b64_tr_b16 v[60:61], v11 offset:22528
    ds_read_b64_tr_b16 v[62:63], v11 offset:23040
    s_waitcnt lgkmcnt(4)
    v_mfma_f32_32x32x16_bf16 v[80:95], v[52:55], v[48:51], v[80:95]
    s_waitcnt lgkmcnt(0)
    s_barrier
    ds_read_b128 v[32:35], v2 offset:40960
    ds_read_b64_tr_b16 v[36:37], v10 offset:0
    ds_read_b64_tr_b16 v[38:39], v10 offset:512
    v_mfma_f32_32x32x16_bf16 v[96:111], v[48:51], v[56:59], v[96:111]
    ds_read_b64_tr_b16 v[40:41], v10 offset:8192
    ds_read_b64_tr_b16 v[42:43], v10 offset:8704
    v_mfma_f32_32x32x16_bf16 v[112:127], v[48:51], v[60:63], v[112:127]
    ds_read_b64_tr_b16 v[44:45], v10 offset:16384
    ds_read_b64_tr_b16 v[46:47], v10 offset:16896
    s_waitcnt lgkmcnt(4)
    v_mfma_f32_32x32x16_bf16 v[80:95], v[36:39], v[32:35], v[80:95]
    ds_read_b128 v[48:51], v3 offset:40960
    ds_read_b64_tr_b16 v[52:53], v10 offset:2048
    ds_read_b64_tr_b16 v[54:55], v10 offset:2560
    s_waitcnt lgkmcnt(5)
    v_mfma_f32_32x32x16_bf16 v[96:111], v[32:35], v[40:43], v[96:111]
    ds_read_b64_tr_b16 v[56:57], v10 offset:10240
    ds_read_b64_tr_b16 v[58:59], v10 offset:10752
    s_waitcnt lgkmcnt(5)
    v_mfma_f32_32x32x16_bf16 v[112:127], v[32:35], v[44:47], v[112:127]
    ds_read_b64_tr_b16 v[60:61], v10 offset:18432
    ds_read_b64_tr_b16 v[62:63], v10 offset:18944
    s_waitcnt lgkmcnt(4)
    v_mfma_f32_32x32x16_bf16 v[80:95], v[52:55], v[48:51], v[80:95]
    ds_read_b128 v[32:35], v4 offset:40960
    ds_read_b64_tr_b16 v[36:37], v10 offset:4096
    ds_read_b64_tr_b16 v[38:39], v10 offset:4608
    s_waitcnt lgkmcnt(5)
    v_mfma_f32_32x32x16_bf16 v[96:111], v[48:51], v[56:59], v[96:111]
    ds_read_b64_tr_b16 v[40:41], v10 offset:12288
    ds_read_b64_tr_b16 v[42:43], v10 offset:12800
    s_waitcnt lgkmcnt(5)
    v_mfma_f32_32x32x16_bf16 v[112:127], v[48:51], v[60:63], v[112:127]
    ds_read_b64_tr_b16 v[44:45], v10 offset:20480
    ds_read_b64_tr_b16 v[46:47], v10 offset:20992
    s_waitcnt lgkmcnt(4)
    v_mfma_f32_32x32x16_bf16 v[80:95], v[36:39], v[32:35], v[80:95]
    ds_read_b128 v[48:51], v5 offset:40960
    ds_read_b64_tr_b16 v[52:53], v10 offset:6144
    ds_read_b64_tr_b16 v[54:55], v10 offset:6656
    s_waitcnt lgkmcnt(5)
    v_mfma_f32_32x32x16_bf16 v[96:111], v[32:35], v[40:43], v[96:111]
    ds_read_b64_tr_b16 v[56:57], v10 offset:14336
    ds_read_b64_tr_b16 v[58:59], v10 offset:14848
    s_waitcnt lgkmcnt(5)
    v_mfma_f32_32x32x16_bf16 v[112:127], v[32:35], v[44:47], v[112:127]
    ds_read_b64_tr_b16 v[60:61], v10 offset:22528
    ds_read_b64_tr_b16 v[62:63], v10 offset:23040
    s_waitcnt lgkmcnt(4)
    v_mfma_f32_32x32x16_bf16 v[80:95], v[52:55], v[48:51], v[80:95]
    s_waitcnt lgkmcnt(0)
    s_barrier
    s_setprio 3
    ds_read_b128 v[32:35], v2 offset:49152
    ds_read_b64_tr_b16 v[36:37], v10 offset:24576
    ds_read_b64_tr_b16 v[38:39], v10 offset:25088
    v_mfma_f32_32x32x16_bf16 v[96:111], v[48:51], v[56:59], v[96:111]
    ds_read_b64_tr_b16 v[40:41], v10 offset:32768
    ds_read_b64_tr_b16 v[42:43], v10 offset:33280
    v_mfma_f32_32x32x16_bf16 v[112:127], v[48:51], v[60:63], v[112:127]
    ds_read_b64_tr_b16 v[44:45], v10 offset:40960
    ds_read_b64_tr_b16 v[46:47], v10 offset:41472
    s_waitcnt lgkmcnt(4)
    v_mfma_f32_32x32x16_bf16 v[80:95], v[36:39], v[32:35], v[80:95]
    ds_read_b128 v[48:51], v3 offset:49152
    ds_read_b64_tr_b16 v[52:53], v10 offset:26624
    ds_read_b64_tr_b16 v[54:55], v10 offset:27136
    s_waitcnt lgkmcnt(5)
    v_mfma_f32_32x32x16_bf16 v[96:111], v[32:35], v[40:43], v[96:111]
    ds_read_b64_tr_b16 v[56:57], v10 offset:34816
    ds_read_b64_tr_b16 v[58:59], v10 offset:35328
    s_waitcnt lgkmcnt(5)
    v_mfma_f32_32x32x16_bf16 v[112:127], v[32:35], v[44:47], v[112:127]
    ds_read_b64_tr_b16 v[60:61], v10 offset:43008
    ds_read_b64_tr_b16 v[62:63], v10 offset:43520
    s_waitcnt lgkmcnt(4)
    v_mfma_f32_32x32x16_bf16 v[80:95], v[52:55], v[48:51], v[80:95]
    ds_read_b128 v[32:35], v4 offset:49152
    ds_read_b64_tr_b16 v[36:37], v10 offset:28672
    ds_read_b64_tr_b16 v[38:39], v10 offset:29184
    s_waitcnt lgkmcnt(5)
    v_mfma_f32_32x32x16_bf16 v[96:111], v[48:51], v[56:59], v[96:111]
    ds_read_b64_tr_b16 v[40:41], v10 offset:36864
    ds_read_b64_tr_b16 v[42:43], v10 offset:37376
    s_waitcnt lgkmcnt(5)
    v_mfma_f32_32x32x16_bf16 v[112:127], v[48:51], v[60:63], v[112:127]
    ds_read_b64_tr_b16 v[44:45], v10 offset:45056
    ds_read_b64_tr_b16 v[46:47], v10 offset:45568
    s_waitcnt lgkmcnt(4)
    v_mfma_f32_32x32x16_bf16 v[80:95], v[36:39], v[32:35], v[80:95]
    ds_read_b128 v[48:51], v5 offset:49152
    ds_read_b64_tr_b16 v[52:53], v10 offset:30720
    ds_read_b64_tr_b16 v[54:55], v10 offset:31232
    s_waitcnt lgkmcnt(5)
    v_mfma_f32_32x32x16_bf16 v[96:111], v[32:35], v[40:43], v[96:111]
    ds_read_b64_tr_b16 v[56:57], v10 offset:38912
    ds_read_b64_tr_b16 v[58:59], v10 offset:39424
    s_waitcnt lgkmcnt(5)
    v_mfma_f32_32x32x16_bf16 v[112:127], v[32:35], v[44:47], v[112:127]
    ds_read_b64_tr_b16 v[60:61], v10 offset:47104
    ds_read_b64_tr_b16 v[62:63], v10 offset:47616
    s_waitcnt lgkmcnt(4)
    v_mfma_f32_32x32x16_bf16 v[80:95], v[52:55], v[48:51], v[80:95]
    s_waitcnt lgkmcnt(0)
    s_barrier
    ds_read_b128 v[32:35], v2 offset:57344
    ds_read_b64_tr_b16 v[36:37], v11 offset:0
    ds_read_b64_tr_b16 v[38:39], v11 offset:512
    v_mfma_f32_32x32x16_bf16 v[96:111], v[48:51], v[56:59], v[96:111]
    ds_read_b64_tr_b16 v[40:41], v11 offset:8192
    ds_read_b64_tr_b16 v[42:43], v11 offset:8704
    v_mfma_f32_32x32x16_bf16 v[112:127], v[48:51], v[60:63], v[112:127]
    ds_read_b64_tr_b16 v[44:45], v11 offset:16384
    ds_read_b64_tr_b16 v[46:47], v11 offset:16896
    s_waitcnt lgkmcnt(4)
    v_mfma_f32_32x32x16_bf16 v[80:95], v[36:39], v[32:35], v[80:95]
    ds_read_b128 v[48:51], v3 offset:57344
    ds_read_b64_tr_b16 v[52:53], v11 offset:2048
    ds_read_b64_tr_b16 v[54:55], v11 offset:2560
    s_waitcnt lgkmcnt(5)
    v_mfma_f32_32x32x16_bf16 v[96:111], v[32:35], v[40:43], v[96:111]
    ds_read_b64_tr_b16 v[56:57], v11 offset:10240
    ds_read_b64_tr_b16 v[58:59], v11 offset:10752
    s_waitcnt lgkmcnt(5)
    v_mfma_f32_32x32x16_bf16 v[112:127], v[32:35], v[44:47], v[112:127]
    ds_read_b64_tr_b16 v[60:61], v11 offset:18432
    ds_read_b64_tr_b16 v[62:63], v11 offset:18944
    s_waitcnt lgkmcnt(4)
    v_mfma_f32_32x32x16_bf16 v[80:95], v[52:55], v[48:51], v[80:95]
    ds_read_b128 v[32:35], v4 offset:57344
    ds_read_b64_tr_b16 v[36:37], v11 offset:4096
    ds_read_b64_tr_b16 v[38:39], v11 offset:4608
    s_waitcnt lgkmcnt(5)
    v_mfma_f32_32x32x16_bf16 v[96:111], v[48:51], v[56:59], v[96:111]
    ds_read_b64_tr_b16 v[40:41], v11 offset:12288
    ds_read_b64_tr_b16 v[42:43], v11 offset:12800
    s_waitcnt lgkmcnt(5)
    v_mfma_f32_32x32x16_bf16 v[112:127], v[48:51], v[60:63], v[112:127]
    ds_read_b64_tr_b16 v[44:45], v11 offset:20480
    ds_read_b64_tr_b16 v[46:47], v11 offset:20992
    s_waitcnt lgkmcnt(4)
    v_mfma_f32_32x32x16_bf16 v[80:95], v[36:39], v[32:35], v[80:95]
    ds_read_b128 v[48:51], v5 offset:57344
    ds_read_b64_tr_b16 v[52:53], v11 offset:6144
    ds_read_b64_tr_b16 v[54:55], v11 offset:6656
    s_waitcnt lgkmcnt(5)
    v_mfma_f32_32x32x16_bf16 v[96:111], v[32:35], v[40:43], v[96:111]
    ds_read_b64_tr_b16 v[56:57], v11 offset:14336
    ds_read_b64_tr_b16 v[58:59], v11 offset:14848
    s_waitcnt lgkmcnt(5)
    v_mfma_f32_32x32x16_bf16 v[112:127], v[32:35], v[44:47], v[112:127]
    ds_read_b64_tr_b16 v[60:61], v11 offset:22528
    ds_read_b64_tr_b16 v[62:63], v11 offset:23040
    s_waitcnt lgkmcnt(4)
    v_mfma_f32_32x32x16_bf16 v[80:95], v[52:55], v[48:51], v[80:95]
    s_waitcnt lgkmcnt(0)
    v_mfma_f32_32x32x16_bf16 v[96:111], v[48:51], v[56:59], v[96:111]
    v_mfma_f32_32x32x16_bf16 v[112:127], v[48:51], v[60:63], v[112:127]
    v_readfirstlane_b32 s57, v25
    ds_add_u32 v24, v23 offset:63232
    s_nop 8
    v_pk_fma_f32 v[128:129], v[96:97], s[58:59], s[58:59] neg_lo:[0,0,1] neg_hi:[0,0,1]
    v_pk_fma_f32 v[130:131], v[98:99], s[58:59], s[58:59] neg_lo:[0,0,1] neg_hi:[0,0,1]
    v_pk_fma_f32 v[132:133], v[100:101], s[58:59], s[58:59] neg_lo:[0,0,1] neg_hi:[0,0,1]
    v_pk_fma_f32 v[134:135], v[102:103], s[58:59], s[58:59] neg_lo:[0,0,1] neg_hi:[0,0,1]
    v_exp_f32_e64 v128, v128 clamp
    v_exp_f32_e64 v129, v129 clamp
    v_exp_f32_e64 v130, v130 clamp
    v_exp_f32_e64 v131, v131 clamp
    v_exp_f32_e64 v132, v132 clamp
    v_exp_f32_e64 v133, v133 clamp
    v_exp_f32_e64 v134, v134 clamp
    v_exp_f32_e64 v135, v135 clamp
    v_max_f32 v128, v128, v96
    v_max_f32 v129, v129, v97
    v_max_f32 v130, v130, v98
    v_max_f32 v131, v131, v99
    v_max_f32 v132, v132, v100
    v_max_f32 v133, v133, v101
    v_max_f32 v134, v134, v102
    v_max_f32 v135, v135, v103
    v_pk_add_f32 v[128:129], v[128:129], s[60:61]
    v_pk_add_f32 v[130:131], v[130:131], s[60:61]
    v_pk_add_f32 v[132:133], v[132:133], s[60:61]
    v_pk_add_f32 v[134:135], v[134:135], s[60:61]
    v_cvt_pk_bf16_f32 v32, v128, v129
    v_cvt_pk_bf16_f32 v33, v130, v131
    v_cvt_pk_bf16_f32 v34, v132, v133
    v_cvt_pk_bf16_f32 v35, v134, v135
    v_cvt_pk_bf16_f32 v40, v112, v113
    v_cvt_pk_bf16_f32 v41, v114, v115
    v_cvt_pk_bf16_f32 v42, v116, v117
    v_cvt_pk_bf16_f32 v43, v118, v119
    v_cvt_pk_bf16_f32 v44, v120, v121
    v_cvt_pk_bf16_f32 v45, v122, v123
    v_cvt_pk_bf16_f32 v46, v124, v125
    v_cvt_pk_bf16_f32 v47, v126, v127
    v_pk_fma_f32 v[128:129], v[104:105], s[58:59], s[58:59] neg_lo:[0,0,1] neg_hi:[0,0,1]
    v_pk_fma_f32 v[130:131], v[106:107], s[58:59], s[58:59] neg_lo:[0,0,1] neg_hi:[0,0,1]
    v_pk_fma_f32 v[132:133], v[108:109], s[58:59], s[58:59] neg_lo:[0,0,1] neg_hi:[0,0,1]
    v_pk_fma_f32 v[134:135], v[110:111], s[58:59], s[58:59] neg_lo:[0,0,1] neg_hi:[0,0,1]
    v_exp_f32_e64 v128, v128 clamp
    v_exp_f32_e64 v129, v129 clamp
    v_exp_f32_e64 v130, v130 clamp
    v_exp_f32_e64 v131, v131 clamp
    v_exp_f32_e64 v132, v132 clamp
    v_exp_f32_e64 v133, v133 clamp
    v_exp_f32_e64 v134, v134 clamp
    v_exp_f32_e64 v135, v135 clamp
    v_max_f32 v128, v128, v104
    v_max_f32 v129, v129, v105
    v_max_f32 v130, v130, v106
    v_max_f32 v131, v131, v107
    v_max_f32 v132, v132, v108
    v_max_f32 v133, v133, v109
    v_max_f32 v134, v134, v110
    v_max_f32 v135, v135, v111
    v_pk_add_f32 v[128:129], v[128:129], s[60:61]
    v_pk_add_f32 v[130:131], v[130:131], s[60:61]
    v_pk_add_f32 v[132:133], v[132:133], s[60:61]
    v_pk_add_f32 v[134:135], v[134:135], s[60:61]
    v_cvt_pk_bf16_f32 v36, v128, v129
    v_cvt_pk_bf16_f32 v37, v130, v131
    v_cvt_pk_bf16_f32 v38, v132, v133
    v_cvt_pk_bf16_f32 v39, v134, v135
    s_cmp_ge_u32 s44, 2
    s_cbranch_scc1 KV0
    ds_write_b128 v12, v[32:35] offset:49152
    ds_write_b128 v12, v[36:39] offset:50176
    ds_write_b128 v12, v[40:43] offset:51200
    ds_write_b128 v12, v[44:47] offset:52224
    ds_write_b32 v13, v23 offset:64000
    s_branch KV1
KV0:
    v_mfma_f32_32x32x16_bf16 v[136:151], v[32:35], v[40:43], 0
    v_mfma_f32_32x32x16_bf16 v[152:167], v[32:35], v[28:31], 0
    v_mfma_f32_32x32x16_bf16 v[136:151], v[36:39], v[44:47], v[136:151]
    v_mfma_f32_32x32x16_bf16 v[152:167], v[36:39], v[28:31], v[152:167]
XW:
    ds_read_b32 v22, v13 offset:64000
    s_waitcnt lgkmcnt(0)
    v_cmp_ne_u32 vcc, 1, v22
    s_cbranch_vccz XW_G
    s_add_u32 s67, s67, 1
    s_cmp_gt_u32 s67, 0x100000
    s_cbranch_scc1 END
    s_sleep 1
    s_branch XW
XW_G:
    ds_read_b128 v[48:51], v12 offset:49152
    ds_read_b128 v[52:55], v12 offset:50176
    ds_read_b128 v[56:59], v12 offset:51200
    ds_read_b128 v[60:63], v12 offset:52224
    s_waitcnt lgkmcnt(0)
    v_mfma_f32_32x32x16_bf16 v[136:151], v[48:51], v[56:59], v[136:151]
    v_mfma_f32_32x32x16_bf16 v[152:167], v[48:51], v[28:31], v[152:167]
    v_mfma_f32_32x32x16_bf16 v[136:151], v[52:55], v[60:63], v[136:151]
    v_mfma_f32_32x32x16_bf16 v[152:167], v[52:55], v[28:31], v[152:167]
    s_mov_b32 exec_lo, 0xffff0000
    s_mov_b32 exec_hi, 0xffff0000
    s_nop 8
    v_pk_mov_b32 v[136:137], v[144:145], v[144:145] op_sel:[0,1]
    v_pk_mov_b32 v[138:139], v[146:147], v[146:147] op_sel:[0,1]
    v_pk_mov_b32 v[140:141], v[148:149], v[148:149] op_sel:[0,1]
    v_pk_mov_b32 v[142:143], v[150:151], v[150:151] op_sel:[0,1]
    s_mov_b64 exec, -1
    buffer_store_dwordx4 v[136:139], v27, s[28:31], s64 offen offset:0 sc1
    buffer_store_dwordx4 v[140:143], v27, s[28:31], s64 offen offset:1024 sc1
    s_mov_b32 exec_lo, 2
    s_mov_b32 exec_hi, 2
    v_pk_mov_b32 v[152:153], v[156:157], v[156:157] op_sel:[0,1]
    v_pk_mov_b32 v[154:155], v[158:159], v[158:159] op_sel:[0,1]
    s_mov_b32 exec_lo, 4
    s_mov_b32 exec_hi, 4
    v_pk_mov_b32 v[152:153], v[160:161], v[160:161] op_sel:[0,1]
    v_pk_mov_b32 v[154:155], v[162:163], v[162:163] op_sel:[0,1]
    s_mov_b32 exec_lo, 8
    s_mov_b32 exec_hi, 8
    v_pk_mov_b32 v[152:153], v[164:165], v[164:165] op_sel:[0,1]
    v_pk_mov_b32 v[154:155], v[166:167], v[166:167] op_sel:[0,1]
    s_mov_b32 exec_lo, 15
    s_mov_b32 exec_hi, 15
    buffer_store_dwordx4 v[152:155], v14, s[28:31], s64 offen offset:2048 sc1
    s_mov_b64 exec, -1
KV1:
    s_lshl_b32 s3, s44, 11
    v_add_u32 v12, s3, v27
    v_pk_fma_f32 v[128:129], v[80:81], s[58:59], s[58:59] neg_lo:[0,0,1] neg_hi:[0,0,1]
    v_pk_fma_f32 v[130:131], v[82:83], s[58:59], s[58:59] neg_lo:[0,0,1] neg_hi:[0,0,1]
    v_pk_fma_f32 v[132:133], v[84:85], s[58:59], s[58:59] neg_lo:[0,0,1] neg_hi:[0,0,1]
    v_pk_fma_f32 v[134:135], v[86:87], s[58:59], s[58:59] neg_lo:[0,0,1] neg_hi:[0,0,1]
    v_exp_f32_e64 v128, v128 clamp
    v_exp_f32_e64 v129, v129 clamp
    v_exp_f32_e64 v130, v130 clamp
    v_exp_f32_e64 v131, v131 clamp
    v_exp_f32_e64 v132, v132 clamp
    v_exp_f32_e64 v133, v133 clamp
    v_exp_f32_e64 v134, v134 clamp
    v_exp_f32_e64 v135, v135 clamp
    v_max_f32 v128, v128, v80
    v_max_f32 v129, v129, v81
    v_max_f32 v130, v130, v82
    v_max_f32 v131, v131, v83
    v_max_f32 v132, v132, v84
    v_max_f32 v133, v133, v85
    v_max_f32 v134, v134, v86
    v_max_f32 v135, v135, v87
    v_pk_add_f32 v[128:129], v[128:129], s[60:61]
    v_pk_add_f32 v[130:131], v[130:131], s[60:61]
    v_pk_add_f32 v[132:133], v[132:133], s[60:61]
    v_pk_add_f32 v[134:135], v[134:135], s[60:61]
    v_cvt_pk_bf16_f32 v64, v128, v129
    v_cvt_pk_bf16_f32 v65, v130, v131
    v_cvt_pk_bf16_f32 v66, v132, v133
    v_cvt_pk_bf16_f32 v67, v134, v135
    ds_write_b128 v12, v[64:67] offset:21504
    v_pk_fma_f32 v[128:129], v[88:89], s[58:59], s[58:59] neg_lo:[0,0,1] neg_hi:[0,0,1]
    v_pk_fma_f32 v[130:131], v[90:91], s[58:59], s[58:59] neg_lo:[0,0,1] neg_hi:[0,0,1]
    v_pk_fma_f32 v[132:133], v[92:93], s[58:59], s[58:59] neg_lo:[0,0,1] neg_hi:[0,0,1]
    v_pk_fma_f32 v[134:135], v[94:95], s[58:59], s[58:59] neg_lo:[0,0,1] neg_hi:[0,0,1]
    v_exp_f32_e64 v128, v128 clamp
    v_exp_f32_e64 v129, v129 clamp
    v_exp_f32_e64 v130, v130 clamp
    v_exp_f32_e64 v131, v131 clamp
    v_exp_f32_e64 v132, v132 clamp
    v_exp_f32_e64 v133, v133 clamp
    v_exp_f32_e64 v134, v134 clamp
    v_exp_f32_e64 v135, v135 clamp
    v_max_f32 v128, v128, v88
    v_max_f32 v129, v129, v89
    v_max_f32 v130, v130, v90
    v_max_f32 v131, v131, v91
    v_max_f32 v132, v132, v92
    v_max_f32 v133, v133, v93
    v_max_f32 v134, v134, v94
    v_max_f32 v135, v135, v95
    v_pk_add_f32 v[128:129], v[128:129], s[60:61]
    v_pk_add_f32 v[130:131], v[130:131], s[60:61]
    v_pk_add_f32 v[132:133], v[132:133], s[60:61]
    v_pk_add_f32 v[134:135], v[134:135], s[60:61]
    v_cvt_pk_bf16_f32 v68, v128, v129
    v_cvt_pk_bf16_f32 v69, v130, v131
    v_cvt_pk_bf16_f32 v70, v132, v133
    v_cvt_pk_bf16_f32 v71, v134, v135
    ds_write_b128 v12, v[68:71] offset:22528
    s_cmp_ge_u32 s44, 2
    s_cbranch_scc0 SIDE
    s_waitcnt vmcnt(0)
    s_mov_b32 exec_hi, 0
    buffer_store_dword v25, v24, s[28:31], s50 offen sc1
    s_mov_b64 exec, -1
SIDE:
    s_and_b32 s3, s2, 7
    s_lshl_b32 s3, s3, 5
    s_lshr_b32 s46, s2, 3
    s_add_u32 s46, s46, s3
    s_lshr_b32 s47, s46, 2
    s_and_b32 s48, s46, 3
    s_lshl_b32 s52, s47, 15
    s_lshl_b32 s10, s48, 7
    s_add_u32 s52, s52, s10
    v_lshlrev_b32 v4, 2, v1
    v_mov_b32 v6, 1
    v_lshlrev_b32 v0, 4, v1
    v_and_b32 v2, 7, v1
    v_lshlrev_b32 v2, 2, v2
    s_mov_b64 s[32:33], s[22:23]
    s_mov_b32 s34, 0x200000
    s_mov_b32 s35, 0x20000
    s_mov_b32 s49, 0
    s_mov_b32 s53, 0
    s_mov_b64 s[50:51], 0
    s_lshr_b32 s13, s46, 3
    s_lshl_b32 s13, s13, 7
POLLST:
    ds_read_b32 v8, v4 offset:62720
    s_waitcnt lgkmcnt(0)
    v_cmp_ne_u32 vcc, 0x6eee8, v8
    s_cbranch_vccz POLLST_G
    s_add_u32 s67, s67, 1
    s_cmp_gt_u32 s67, 0x100000
    s_cbranch_scc1 END
    s_sleep 4
    s_branch POLLST
POLLST_G:
    s_cmp_lt_u32 s2, 68
    s_cbranch_scc0 NORED
    s_cmp_eq_u32 s44, 1
    s_cbranch_scc0 NORED
    s_mul_i32 s3, s2, 15421
    s_lshr_b32 s3, s3, 16
    s_min_u32 s3, s3, 14
    s_lshl_b32 s3, s3, 12
    s_add_u32 s11, s3, 0x4c0000
    v_lshlrev_b32 v7, 7, v1
RG:
    ds_read_b32 v8, v4 offset:58368
    s_waitcnt lgkmcnt(0)
    v_cmp_gt_u32 vcc, 0x37774, v8
    s_cbranch_vccz RG_G
    s_add_u32 s67, s67, 1
    s_cmp_gt_u32 s67, 0x100000
    s_cbranch_scc1 END
    s_sleep 6
    s_branch RG
RG_G:
RKW:
    buffer_load_dword v8, v7, s[28:31], s11 offen sc1
    s_waitcnt vmcnt(0)
    v_cmp_ne_u32 vcc, s57, v8
    s_cbranch_vccz RKW_G
    s_mov_b64 exec, vcc
    s_add_u32 s67, s67, 1
    s_cmp_gt_u32 s67, 0x100000
    s_cbranch_scc1 END
    s_sleep 4
    s_branch RKW
RKW_G:
    s_mov_b64 exec, -1
    v_lshlrev_b32 v7, 3, v1
    s_lshl_b32 s12, s2, 9
    s_add_u32 s12, s12, 0x600000
    buffer_load_dwordx2 v[72:73], v7, s[28:31], s12 offen sc1
    s_add_u32 s12, s12, 34816
    buffer_load_dwordx2 v[74:75], v7, s[28:31], s12 offen sc1
    s_add_u32 s12, s12, 34816
    buffer_load_dwordx2 v[76:77], v7, s[28:31], s12 offen sc1
    s_add_u32 s12, s12, 34816
    buffer_load_dwordx2 v[78:79], v7, s[28:31], s12 offen sc1
    s_add_u32 s12, s12, 34816
    buffer_load_dwordx2 v[80:81], v7, s[28:31], s12 offen sc1
    s_add_u32 s12, s12, 34816
    buffer_load_dwordx2 v[82:83], v7, s[28:31], s12 offen sc1
    s_add_u32 s12, s12, 34816
    buffer_load_dwordx2 v[84:85], v7, s[28:31], s12 offen sc1
    s_add_u32 s12, s12, 34816
    buffer_load_dwordx2 v[86:87], v7, s[28:31], s12 offen sc1
    s_add_u32 s12, s12, 34816
    buffer_load_dwordx2 v[88:89], v7, s[28:31], s12 offen sc1
    s_add_u32 s12, s12, 34816
    buffer_load_dwordx2 v[90:91], v7, s[28:31], s12 offen sc1
    s_add_u32 s12, s12, 34816
    buffer_load_dwordx2 v[92:93], v7, s[28:31], s12 offen sc1
    s_add_u32 s12, s12, 34816
    buffer_load_dwordx2 v[94:95], v7, s[28:31], s12 offen sc1
    s_add_u32 s12, s12, 34816
    buffer_load_dwordx2 v[96:97], v7, s[28:31], s12 offen sc1
    s_add_u32 s12, s12, 34816
    buffer_load_dwordx2 v[98:99], v7, s[28:31], s12 offen sc1
    s_add_u32 s12, s12, 34816
    buffer_load_dwordx2 v[100:101], v7, s[28:31], s12 offen sc1
    s_add_u32 s12, s12, 34816
    buffer_load_dwordx2 v[102:103], v7, s[28:31], s12 offen sc1
    s_add_u32 s12, s12, 34816
    buffer_load_dwordx2 v[104:105], v7, s[28:31], s12 offen sc1
    s_add_u32 s12, s12, 34816
    buffer_load_dwordx2 v[106:107], v7, s[28:31], s12 offen sc1
    s_add_u32 s12, s12, 34816
    buffer_load_dwordx2 v[108:109], v7, s[28:31], s12 offen sc1
    s_add_u32 s12, s12, 34816
    buffer_load_dwordx2 v[110:111], v7, s[28:31], s12 offen sc1
    s_add_u32 s12, s12, 34816
    buffer_load_dwordx2 v[112:113], v7, s[28:31], s12 offen sc1
    s_add_u32 s12, s12, 34816
    buffer_load_dwordx2 v[114:115], v7, s[28:31], s12 offen sc1
    s_add_u32 s12, s12, 34816
    buffer_load_dwordx2 v[116:117], v7, s[28:31], s12 offen sc1
    s_add_u32 s12, s12, 34816
    buffer_load_dwordx2 v[118:119], v7, s[28:31], s12 offen sc1
    s_add_u32 s12, s12, 34816
    buffer_load_dwordx2 v[120:121], v7, s[28:31], s12 offen sc1
    s_add_u32 s12, s12, 34816
    buffer_load_dwordx2 v[122:123], v7, s[28:31], s12 offen sc1
    s_add_u32 s12, s12, 34816
    buffer_load_dwordx2 v[124:125], v7, s[28:31], s12 offen sc1
    s_add_u32 s12, s12, 34816
    buffer_load_dwordx2 v[126:127], v7, s[28:31], s12 offen sc1
    s_add_u32 s12, s12, 34816
    buffer_load_dwordx2 v[128:129], v7, s[28:31], s12 offen sc1
    s_add_u32 s12, s12, 34816
    buffer_load_dwordx2 v[130:131], v7, s[28:31], s12 offen sc1
    s_add_u32 s12, s12, 34816
    buffer_load_dwordx2 v[132:133], v7, s[28:31], s12 offen sc1
    s_add_u32 s12, s12, 34816
    buffer_load_dwordx2 v[134:135], v7, s[28:31], s12 offen sc1
    s_waitcnt vmcnt(0)
    v_pk_add_f32 v[72:73], v[72:73], v[74:75]
    v_pk_add_f32 v[74:75], v[76:77], v[78:79]
    v_pk_add_f32 v[76:77], v[80:81], v[82:83]
    v_pk_add_f32 v[78:79], v[84:85], v[86:87]
    v_pk_add_f32 v[80:81], v[88:89], v[90:91]
    v_pk_add_f32 v[82:83], v[92:93], v[94:95]
    v_pk_add_f32 v[84:85], v[96:97], v[98:99]
    v_pk_add_f32 v[86:87], v[100:101], v[102:103]
    v_pk_add_f32 v[88:89], v[104:105], v[106:107]
    v_pk_add_f32 v[90:91], v[108:109], v[110:111]
    v_pk_add_f32 v[92:93], v[112:113], v[114:115]
    v_pk_add_f32 v[94:95], v[116:117], v[118:119]
    v_pk_add_f32 v[96:97], v[120:121], v[122:123]
    v_pk_add_f32 v[98:99], v[124:125], v[126:127]
    v_pk_add_f32 v[100:101], v[128:129], v[130:131]
    v_pk_add_f32 v[102:103], v[132:133], v[134:135]
    v_pk_add_f32 v[72:73], v[72:73], v[74:75]
    v_pk_add_f32 v[74:75], v[76:77], v[78:79]
    v_pk_add_f32 v[76:77], v[80:81], v[82:83]
    v_pk_add_f32 v[78:79], v[84:85], v[86:87]
    v_pk_add_f32 v[80:81], v[88:89], v[90:91]
    v_pk_add_f32 v[82:83], v[92:93], v[94:95]
    v_pk_add_f32 v[84:85], v[96:97], v[98:99]
    v_pk_add_f32 v[86:87], v[100:101], v[102:103]
    v_pk_add_f32 v[72:73], v[72:73], v[74:75]
    v_pk_add_f32 v[74:75], v[76:77], v[78:79]
    v_pk_add_f32 v[76:77], v[80:81], v[82:83]
    v_pk_add_f32 v[78:79], v[84:85], v[86:87]
    v_pk_add_f32 v[72:73], v[72:73], v[74:75]
    v_pk_add_f32 v[74:75], v[76:77], v[78:79]
    v_pk_add_f32 v[72:73], v[72:73], v[74:75]
    v_cvt_pk_bf16_f32 v72, v72, v73
    s_lshl_b32 s12, s2, 8
    s_add_u32 s12, s12, 0x430000
    buffer_store_dword v72, v4, s[28:31], s12 offen sc1
NORED:
    s_lshl_b32 s10, s46, 5
    s_add_u32 s10, s10, 0x420000
    buffer_load_dword v5, v2, s[28:31], s10 offen sc1
    s_lshl_b32 s54, s44, 14
    s_add_u32 s54, s54, 0x540000
    s_lshl_b32 s55, s48, 2
    s_add_u32 s55, s55, s44
    s_lshl_b32 s55, s55, 15
    s_add_u32 s55, s55, 0x580000
    s_add_u32 s19, s13, 0x4b8000
    s_mov_b32 s3, s55
    buffer_load_dwordx4 v[72:75], v0, s[28:31], s3 offen offset:0 sc1
    buffer_load_dwordx4 v[76:79], v0, s[28:31], s3 offen offset:1024 sc1
    buffer_load_dwordx4 v[80:83], v0, s[28:31], s3 offen offset:2048 sc1
    buffer_load_dwordx4 v[84:87], v0, s[28:31], s3 offen offset:3072 sc1
    s_add_u32 s3, s3, 4096
    buffer_load_dwordx4 v[88:91], v0, s[28:31], s3 offen offset:0 sc1
    buffer_load_dwordx4 v[92:95], v0, s[28:31], s3 offen offset:1024 sc1
    buffer_load_dwordx4 v[96:99], v0, s[28:31], s3 offen offset:2048 sc1
    buffer_load_dwordx4 v[100:103], v0, s[28:31], s3 offen offset:3072 sc1
    s_add_u32 s3, s3, 4096
    buffer_load_dwordx4 v[104:107], v0, s[28:31], s3 offen offset:0 sc1
    buffer_load_dwordx4 v[108:111], v0, s[28:31], s3 offen offset:1024 sc1
    buffer_load_dwordx4 v[112:115], v0, s[28:31], s3 offen offset:2048 sc1
    buffer_load_dwordx4 v[116:119], v0, s[28:31], s3 offen offset:3072 sc1
    s_add_u32 s3, s3, 4096
    buffer_load_dwordx4 v[120:123], v0, s[28:31], s3 offen offset:0 sc1
    buffer_load_dwordx4 v[124:127], v0, s[28:31], s3 offen offset:1024 sc1
    buffer_load_dwordx4 v[128:131], v0, s[28:31], s3 offen offset:2048 sc1
    buffer_load_dwordx4 v[132:135], v0, s[28:31], s3 offen offset:3072 sc1
PKW:
    ds_read_b32 v8, v4 offset:63232
    s_waitcnt lgkmcnt(0)
    v_cmp_ne_u32 vcc, 0x37778, v8
    s_cbranch_vccz PKW_G
    s_add_u32 s67, s67, 1
    s_cmp_gt_u32 s67, 0x100000
    s_cbranch_scc1 END
    s_sleep 4
    s_branch PKW
PKW_G:
    s_mul_i32 s64, s44, 6144
    s_add_u32 s64, s64, 131072
    s_mov_b32 m0, s64
    s_add_u32 s3, s54, 0x32800
    buffer_load_dwordx4 v0, s[28:31], s3 offen offset:0 sc1 lds
    buffer_load_dwordx4 v0, s[28:31], s3 offen offset:1024 sc1 lds
    buffer_load_dwordx4 v0, s[28:31], s3 offen offset:2048 sc1 lds
    buffer_load_dwordx4 v0, s[28:31], s3 offen offset:3072 sc1 lds
    s_add_u32 s3, s3, 4096
    s_add_u32 m0, m0, 4096
    s_nop 0
    buffer_load_dwordx4 v0, s[28:31], s3 offen offset:0 sc1 lds
    buffer_load_dwordx4 v0, s[28:31], s3 offen offset:1024 sc1 lds
    v_lshrrev_b32 v3, 4, v1
    v_lshlrev_b32 v3, 7, v3
    v_lshl_add_u32 v3, v2, 2, v3
    v_bfe_u32 v2, v1, 3, 1
    v_lshl_add_u32 v3, v2, 9, v3
    v_add_u32 v3, 16384, v3
    v_mul_u32_u24 v2, 0xaaaa, v2
    v_add_u32 v2, 0x4444, v2
    s_mov_b32 s58, 0x6eee8
    s_mov_b32 s56, s44
    s_mov_b32 s59, 0x17800000
    s_mov_b32 s60, 0x58000000
    s_lshl_b32 s14, s47, 2
    s_add_u32 s14, s14, s44
    s_lshl_b32 s15, s14, 13
    s_lshl_b32 s10, s48, 7
    s_add_u32 s15, s15, s10
    s_add_u32 s15, s15, 0x800000
    s_lshl_b32 s14, s14, 9
    s_add_u32 s14, s14, 0x480000
    s_waitcnt vmcnt(22)
    v_sub_f32 v5, 1.0, v5
    s_mov_b32 s62, 0
    s_mov_b32 s49, 4
    s_branch A1
BLK:
    s_lshl_b32 m0, s56, 8
    ds_read_b32 v9, v4 offset:61440
    ds_read_addtid_b32 v8 offset:58368
    s_waitcnt lgkmcnt(0)
    v_cmp_ne_u32 vcc, s58, v8
    s_cbranch_vccz DUTY
    v_cmp_ne_u32 vcc, 1, v9
    s_cbranch_vccz GOTF
    s_cmp_eq_u32 s62, 2
    s_cbranch_scc1 PUB
    s_add_u32 s67, s67, 1
    s_cmp_gt_u32 s67, 0x100000
    s_cbranch_scc1 END
    s_sleep 8
    s_branch BLK
DUTY:
    s_cmp_ge_u32 s56, 4
    s_cselect_b32 s3, 4, 0
    s_sub_u32 s3, s56, s3
    s_lshl_b32 s10, s3, 14
    s_add_u32 s10, s10, 65536
    v_add_u32 v7, s10, v0
    s_lshl_b32 m0, s3, 11
    s_nop 0
    ds_read_addtid_b32 v64 offset:0
    ds_read_addtid_b32 v65 offset:256
    ds_read_addtid_b32 v66 offset:512
    ds_read_addtid_b32 v67 offset:768
    ds_read_addtid_b32 v68 offset:1024
    ds_read_addtid_b32 v69 offset:1280
    ds_read_addtid_b32 v70 offset:1536
    ds_read_addtid_b32 v71 offset:1792
    ds_read_b128 v[8:11], v7 offset:0
    ds_read_b128 v[12:15], v7 offset:1024
    ds_read_b128 v[16:19], v7 offset:2048
    ds_read_b128 v[20:23], v7 offset:3072
    ds_read_b128 v[24:27], v7 offset:4096
    ds_read_b128 v[28:31], v7 offset:5120
    s_waitcnt lgkmcnt(6)
    v_pk_add_f32 v[64:65], v[64:65], v[66:67]
    v_pk_add_f32 v[68:69], v[68:69], v[70:71]
    ds_read_b128 v[32:35], v7 offset:6144
    ds_read_b128 v[36:39], v7 offset:7168
    ds_read_b128 v[40:43], v7 offset:8192
    ds_read_b128 v[44:47], v7 offset:9216
    ds_read_b128 v[48:51], v7 offset:10240
    ds_read_b128 v[52:55], v7 offset:11264
    ds_read_b128 v[56:59], v7 offset:12288
    ds_read_b128 v[60:63], v7 offset:13312
    v_pk_add_f32 v[64:65], v[64:65], v[68:69]
    v_add_f32 v6, v64, v65
    s_waitcnt lgkmcnt(10)
    ds_read_b128 v[64:67], v7 offset:14336
    ds_read_b128 v[68:71], v7 offset:15360
    v_subrev_u32 v7, s59, v6
    v_rcp_f32 v6, v6
    v_cmp_le_u32 vcc, s60, v7
    v_pk_add_f32 v[8:9], v[8:9], v[16:17]
    v_pk_add_f32 v[10:11], v[10:11], v[18:19]
    v_pk_add_f32 v[12:13], v[12:13], v[20:21]
    v_pk_add_f32 v[14:15], v[14:15], v[22:23]
    s_or_b64 s[50:51], s[50:51], vcc
    v_mul_f32 v6, v5, v6
    s_waitcnt lgkmcnt(10)
    v_pk_add_f32 v[8:9], v[8:9], v[24:25]
    v_pk_add_f32 v[10:11], v[10:11], v[26:27]
    v_pk_add_f32 v[12:13], v[12:13], v[28:29]
    v_pk_add_f32 v[14:15], v[14:15], v[30:31]
    s_waitcnt lgkmcnt(8)
    v_pk_add_f32 v[8:9], v[8:9], v[32:33]
    v_pk_add_f32 v[10:11], v[10:11], v[34:35]
    v_pk_add_f32 v[12:13], v[12:13], v[36:37]
    v_pk_add_f32 v[14:15], v[14:15], v[38:39]
    s_waitcnt lgkmcnt(6)
    v_pk_add_f32 v[8:9], v[8:9], v[40:41]
    v_pk_add_f32 v[10:11], v[10:11], v[42:43]
    v_pk_add_f32 v[12:13], v[12:13], v[44:45]
    v_pk_add_f32 v[14:15], v[14:15], v[46:47]
    s_waitcnt lgkmcnt(4)
    v_pk_add_f32 v[8:9], v[8:9], v[48:49]
    v_pk_add_f32 v[10:11], v[10:11], v[50:51]
    v_pk_add_f32 v[12:13], v[12:13], v[52:53]
    v_pk_add_f32 v[14:15], v[14:15], v[54:55]
    s_waitcnt lgkmcnt(2)
    v_pk_add_f32 v[8:9], v[8:9], v[56:57]
    v_pk_add_f32 v[10:11], v[10:11], v[58:59]
    v_pk_add_f32 v[12:13], v[12:13], v[60:61]
    v_pk_add_f32 v[14:15], v[14:15], v[62:63]
    s_waitcnt lgkmcnt(0)
    v_pk_add_f32 v[8:9], v[8:9], v[64:65]
    v_pk_add_f32 v[10:11], v[10:11], v[66:67]
    v_pk_add_f32 v[12:13], v[12:13], v[68:69]
    v_pk_add_f32 v[14:15], v[14:15], v[70:71]
    v_pk_mul_f32 v[8:9], v[8:9], v[6:7] op_sel_hi:[1,0]
    v_pk_mul_f32 v[10:11], v[10:11], v[6:7] op_sel_hi:[1,0]
    v_pk_mul_f32 v[12:13], v[12:13], v[6:7] op_sel_hi:[1,0]
    v_pk_mul_f32 v[14:15], v[14:15], v[6:7] op_sel_hi:[1,0]
    v_cvt_pk_bf16_f32 v16, v8, v9
    v_cvt_pk_bf16_f32 v17, v10, v11
    v_cvt_pk_bf16_f32 v18, v12, v13
    v_cvt_pk_bf16_f32 v19, v14, v15
    v_mov_b32 v6, 1
    s_lshl_b32 m0, s56, 8
    s_mov_b32 s10, s56
    s_add_u32 s56, s56, 4
    s_cmp_eq_u32 s56, 6
    s_cselect_b32 s56, 7, s56
    s_cmp_lt_u32 s10, 4
    s_cbranch_scc1 DUTX
    s_lshl_b32 s3, s10, 10
    v_add_u32 v7, s3, v0
    ds_write_b128 v7, v[16:19] offset:12288
    ds_write_addtid_b32 v6 offset:60416
    s_cmp_eq_u32 s62, 1
    s_cbranch_scc1 POLLOB
    s_cmp_eq_u32 s62, 2
    s_cbranch_scc1 PUB
    s_cmp_eq_u32 s10, s49
    s_cbranch_scc0 BLK
GOTF:
    ds_read_b128 v[24:27], v3
    v_add_u32 v4, 256, v4
    v_add_u32 v3, 1024, v3
    s_waitcnt lgkmcnt(0)
    s_mov_b32 s3, s54
    s_add_u32 s54, s54, 0x10000
    s_waitcnt vmcnt(14)
    v_smfmac_f32_16x16x64_bf16 v[136:139], v[24:27], v[72:79], v2
    buffer_load_dwordx4 v[72:75], v0, s[28:31], s3 offen offset:0 sc1
    buffer_load_dwordx4 v[76:79], v0, s[28:31], s3 offen offset:1024 sc1
    s_waitcnt vmcnt(14)
    v_smfmac_f32_16x16x64_bf16 v[140:143], v[24:27], v[80:87], v2
    buffer_load_dwordx4 v[80:83], v0, s[28:31], s3 offen offset:2048 sc1
    buffer_load_dwordx4 v[84:87], v0, s[28:31], s3 offen offset:3072 sc1
    s_add_u32 s3, s3, 4096
    s_waitcnt vmcnt(14)
    v_smfmac_f32_16x16x64_bf16 v[144:147], v[24:27], v[88:95], v2
    buffer_load_dwordx4 v[88:91], v0, s[28:31], s3 offen offset:0 sc1
    buffer_load_dwordx4 v[92:95], v0, s[28:31], s3 offen offset:1024 sc1
    s_waitcnt vmcnt(14)
    v_smfmac_f32_16x16x64_bf16 v[148:151], v[24:27], v[96:103], v2
    buffer_load_dwordx4 v[96:99], v0, s[28:31], s3 offen offset:2048 sc1
    buffer_load_dwordx4 v[100:103], v0, s[28:31], s3 offen offset:3072 sc1
    s_add_u32 s3, s3, 4096
    s_waitcnt vmcnt(14)
    v_smfmac_f32_16x16x64_bf16 v[152:155], v[24:27], v[104:111], v2
    buffer_load_dwordx4 v[104:107], v0, s[28:31], s3 offen offset:0 sc1
    buffer_load_dwordx4 v[108:111], v0, s[28:31], s3 offen offset:1024 sc1
    s_cmp_eq_u32 s62, 2
    s_cbranch_scc1 PUBM
PUBR:
    s_waitcnt vmcnt(14)
    v_smfmac_f32_16x16x64_bf16 v[156:159], v[24:27], v[112:119], v2
    buffer_load_dwordx4 v[112:115], v0, s[28:31], s3 offen offset:2048 sc1
    buffer_load_dwordx4 v[116:119], v0, s[28:31], s3 offen offset:3072 sc1
    s_add_u32 s3, s3, 4096
    s_waitcnt vmcnt(14)
    v_smfmac_f32_16x16x64_bf16 v[160:163], v[24:27], v[120:127], v2
    buffer_load_dwordx4 v[120:123], v0, s[28:31], s3 offen offset:0 sc1
    buffer_load_dwordx4 v[124:127], v0, s[28:31], s3 offen offset:1024 sc1
    s_waitcnt vmcnt(14)
    v_smfmac_f32_16x16x64_bf16 v[164:167], v[24:27], v[128:135], v2
    buffer_load_dwordx4 v[128:131], v0, s[28:31], s3 offen offset:2048 sc1
    buffer_load_dwordx4 v[132:135], v0, s[28:31], s3 offen offset:3072 sc1
    s_add_u32 s49, s49, 1
    s_cmp_eq_u32 s49, 6
    s_cbranch_scc0 BLK
B6:
    v_and_b32 v62, 3, v1
    v_lshlrev_b32 v62, 7, v62
    buffer_load_dword v64, v62, s[28:31], s14 offen sc1
    v_and_b32 v63, 15, v1
    v_lshlrev_b32 v63, 9, v63
    v_bfe_u32 v7, v1, 4, 1
    v_lshl_add_u32 v63, v7, 6, v63
    v_lshrrev_b32 v7, 5, v1
    v_lshl_add_u32 v63, v7, 5, v63
    s_lshl_b32 s65, s46, 13
    s_lshl_b32 s10, s44, 8
    s_add_u32 s65, s65, s10
    v_lshlrev_b32 v4, 2, v1
    v_and_b32 v6, 15, v1
    v_lshlrev_b32 v6, 4, v6
    v_bfe_u32 v7, v1, 4, 1
    v_lshl_add_u32 v6, v7, 12, v6
    v_lshrrev_b32 v7, 5, v1
    v_lshl_add_u32 v1, v7, 11, v6
    v_mov_b32 v6, 1
    v_add_u32 v46, 0xb800, v3
    v_subrev_u32 v47, 18432, v3
    v_lshrrev_b32 v47, 2, v47
    v_add_u32 v3, 1024, v3
C6H:
    ds_read_b32 v8, v4 offset:62976
    s_waitcnt lgkmcnt(0)
    v_cmp_ne_u32 vcc, 0x37774, v8
    s_cbranch_vccz C6H_G
    s_add_u32 s67, s67, 1
    s_cmp_gt_u32 s67, 0x100000
    s_cbranch_scc1 END
    s_sleep 2
    s_branch C6H
C6H_G:
    ds_read2st64_b32 v[58:59], v47 offset0:16 offset1:17
    ds_read2st64_b32 v[60:61], v47 offset0:18 offset1:19
    ds_read_b128 v[8:11], v46 offset:32768
    ds_read_b128 v[12:15], v46 offset:33792
    ds_read_b128 v[16:19], v46 offset:34816
    ds_read_b128 v[20:23], v46 offset:35840
    ds_read_b128 v[24:27], v46 offset:36864
    ds_read_b128 v[28:31], v46 offset:37888
    ds_read_b128 v[32:35], v46 offset:38912
    ds_read_b128 v[36:39], v46 offset:39936
    s_waitcnt lgkmcnt(4)
    v_pk_add_f32 v[56:57], v[58:59], v[60:61]
    v_pk_add_f32 v[48:49], v[8:9], v[16:17]
    v_pk_add_f32 v[50:51], v[10:11], v[18:19]
    v_pk_add_f32 v[52:53], v[12:13], v[20:21]
    v_pk_add_f32 v[54:55], v[14:15], v[22:23]
    s_waitcnt lgkmcnt(0)
    v_pk_add_f32 v[24:25], v[24:25], v[32:33]
    v_pk_add_f32 v[26:27], v[26:27], v[34:35]
    v_pk_add_f32 v[28:29], v[28:29], v[36:37]
    v_pk_add_f32 v[30:31], v[30:31], v[38:39]
    v_pk_add_f32 v[48:49], v[48:49], v[24:25]
    v_pk_add_f32 v[50:51], v[50:51], v[26:27]
    v_pk_add_f32 v[52:53], v[52:53], v[28:29]
    v_pk_add_f32 v[54:55], v[54:55], v[30:31]
C6:
    ds_read_b32 v8, v4 offset:59904
    s_waitcnt lgkmcnt(0)
    v_cmp_ne_u32 vcc, s58, v8
    s_cbranch_vccz C6_G
    s_add_u32 s67, s67, 1
    s_cmp_gt_u32 s67, 0x100000
    s_cbranch_scc1 END
    s_sleep 1
    s_branch C6
C6_G:
    ds_read2st64_b32 v[58:59], v47 offset0:20 offset1:21
    ds_read2st64_b32 v[60:61], v47 offset0:22 offset1:23
    ds_read_b128 v[8:11], v46 offset:40960
    ds_read_b128 v[12:15], v46 offset:41984
    ds_read_b128 v[16:19], v46 offset:43008
    ds_read_b128 v[20:23], v46 offset:44032
    ds_read_b128 v[24:27], v46 offset:45056
    ds_read_b128 v[28:31], v46 offset:46080
    ds_read_b128 v[32:35], v46 offset:47104
    ds_read_b128 v[36:39], v46 offset:48128
    s_waitcnt lgkmcnt(8)
    v_pk_add_f32 v[58:59], v[58:59], v[60:61]
    v_pk_add_f32 v[56:57], v[56:57], v[58:59]
    v_add_f32 v56, v56, v57
    v_subrev_u32 v7, s59, v56
    v_rcp_f32 v56, v56
    v_cmp_le_u32 vcc, s60, v7
    s_waitcnt lgkmcnt(6)
    v_pk_add_f32 v[48:49], v[48:49], v[8:9]
    v_pk_add_f32 v[50:51], v[50:51], v[10:11]
    v_pk_add_f32 v[52:53], v[52:53], v[12:13]
    v_pk_add_f32 v[54:55], v[54:55], v[14:15]
    v_mul_f32 v56, v5, v56
    s_or_b64 s[50:51], s[50:51], vcc
    s_waitcnt lgkmcnt(4)
    v_pk_add_f32 v[48:49], v[48:49], v[16:17]
    v_pk_add_f32 v[50:51], v[50:51], v[18:19]
    v_pk_add_f32 v[52:53], v[52:53], v[20:21]
    v_pk_add_f32 v[54:55], v[54:55], v[22:23]
    s_waitcnt lgkmcnt(2)
    v_pk_add_f32 v[48:49], v[48:49], v[24:25]
    v_pk_add_f32 v[50:51], v[50:51], v[26:27]
    v_pk_add_f32 v[52:53], v[52:53], v[28:29]
    v_pk_add_f32 v[54:55], v[54:55], v[30:31]
    s_waitcnt lgkmcnt(0)
    v_pk_add_f32 v[48:49], v[48:49], v[32:33]
    v_pk_add_f32 v[50:51], v[50:51], v[34:35]
    v_pk_add_f32 v[52:53], v[52:53], v[36:37]
    v_pk_add_f32 v[54:55], v[54:55], v[38:39]
    v_pk_mul_f32 v[48:49], v[48:49], v[56:57] op_sel_hi:[1,0]
    v_pk_mul_f32 v[50:51], v[50:51], v[56:57] op_sel_hi:[1,0]
    v_pk_mul_f32 v[52:53], v[52:53], v[56:57] op_sel_hi:[1,0]
    v_pk_mul_f32 v[54:55], v[54:55], v[56:57] op_sel_hi:[1,0]
    v_cvt_pk_bf16_f32 v24, v48, v49
    v_cvt_pk_bf16_f32 v25, v50, v51
    v_cvt_pk_bf16_f32 v26, v52, v53
    v_cvt_pk_bf16_f32 v27, v54, v55
    v_add_u32 v7, s64, v0
    s_mov_b32 s3, s54
    s_waitcnt vmcnt(0)
    v_cmp_ne_u32 vcc, s57, v64
    s_cbranch_vccz GLW_G
GLW:
    buffer_load_dword v64, v62, s[28:31], s14 offen sc1
    s_waitcnt vmcnt(0)
    v_cmp_ne_u32 vcc, s57, v64
    s_cbranch_vccz GLW_G
    s_mov_b64 exec, vcc
    s_add_u32 s67, s67, 1
    s_cmp_gt_u32 s67, 0x100000
    s_cbranch_scc1 END
    s_sleep 4
    s_branch GLW
GLW_G:
    s_mov_b64 exec, -1
    buffer_load_dwordx4 v[64:67], v63, s[28:31], s15 offen offset:0 sc1
    buffer_load_dwordx4 v[68:71], v63, s[28:31], s15 offen offset:16 sc1
    v_smfmac_f32_16x16x64_bf16 v[136:139], v[24:27], v[72:79], v2
    buffer_load_dwordx4 v[72:75], v0, s[28:31], s3 offen offset:0 sc1
    buffer_load_dwordx4 v[76:79], v0, s[28:31], s3 offen offset:1024 sc1
    v_smfmac_f32_16x16x64_bf16 v[140:143], v[24:27], v[80:87], v2
    buffer_load_dwordx4 v[80:83], v0, s[28:31], s3 offen offset:2048 sc1
    buffer_load_dwordx4 v[84:87], v0, s[28:31], s3 offen offset:3072 sc1
    v_smfmac_f32_16x16x64_bf16 v[144:147], v[24:27], v[88:95], v2
    s_add_u32 s3, s3, 4096
    buffer_load_dwordx4 v[88:91], v0, s[28:31], s3 offen offset:0 sc1
    buffer_load_dwordx4 v[92:95], v0, s[28:31], s3 offen offset:1024 sc1
    v_smfmac_f32_16x16x64_bf16 v[148:151], v[24:27], v[96:103], v2
    buffer_load_dwordx4 v[96:99], v0, s[28:31], s3 offen offset:2048 sc1
    buffer_load_dwordx4 v[100:103], v0, s[28:31], s3 offen offset:3072 sc1
    v_smfmac_f32_16x16x64_bf16 v[152:155], v[24:27], v[104:111], v2
    s_add_u32 s3, s3, 4096
    buffer_load_dwordx4 v[104:107], v0, s[28:31], s3 offen offset:0 sc1
    buffer_load_dwordx4 v[108:111], v0, s[28:31], s3 offen offset:1024 sc1
    v_smfmac_f32_16x16x64_bf16 v[156:159], v[24:27], v[112:119], v2
    ds_read_b128 v[112:115], v7 offset:0
    ds_read_b128 v[116:119], v7 offset:1024
    v_smfmac_f32_16x16x64_bf16 v[160:163], v[24:27], v[120:127], v2
    ds_read_b128 v[120:123], v7 offset:2048
    ds_read_b128 v[124:127], v7 offset:3072
    v_smfmac_f32_16x16x64_bf16 v[164:167], v[24:27], v[128:135], v2
    ds_read_b128 v[128:131], v7 offset:4096
    ds_read_b128 v[132:135], v7 offset:5120
    s_cmp_eq_u64 s[50:51], 0
    s_cbranch_scc1 OK6
    ds_write_b32 v4, v6 offset:64256
OK6:
C7:
    ds_read_b32 v8, v4 offset:60160
    s_waitcnt lgkmcnt(0)
    v_cmp_ne_u32 vcc, 0x37774, v8
    s_cbranch_vccz C7_G
    s_add_u32 s67, s67, 1
    s_cmp_gt_u32 s67, 0x100000
    s_cbranch_scc1 END
    s_sleep 1
    s_branch C7
C7_G:
    ds_read2st64_b32 v[58:59], v47 offset0:24 offset1:25
    ds_read2st64_b32 v[60:61], v47 offset0:26 offset1:27
    ds_read_b128 v[8:11], v46 offset:49152
    ds_read_b128 v[12:15], v46 offset:50176
    ds_read_b128 v[16:19], v46 offset:51200
    ds_read_b128 v[20:23], v46 offset:52224
    ds_read_b128 v[24:27], v46 offset:53248
    ds_read_b128 v[28:31], v46 offset:54272
    ds_read_b128 v[32:35], v46 offset:55296
    ds_read_b128 v[36:39], v46 offset:56320
    s_waitcnt lgkmcnt(4)
    v_pk_add_f32 v[56:57], v[58:59], v[60:61]
    v_pk_add_f32 v[48:49], v[8:9], v[16:17]
    v_pk_add_f32 v[50:51], v[10:11], v[18:19]
    v_pk_add_f32 v[52:53], v[12:13], v[20:21]
    v_pk_add_f32 v[54:55], v[14:15], v[22:23]
    s_waitcnt lgkmcnt(0)
    v_pk_add_f32 v[24:25], v[24:25], v[32:33]
    v_pk_add_f32 v[26:27], v[26:27], v[34:35]
    v_pk_add_f32 v[28:29], v[28:29], v[36:37]
    v_pk_add_f32 v[30:31], v[30:31], v[38:39]
    v_pk_add_f32 v[48:49], v[48:49], v[24:25]
    v_pk_add_f32 v[50:51], v[50:51], v[26:27]
    v_pk_add_f32 v[52:53], v[52:53], v[28:29]
    v_pk_add_f32 v[54:55], v[54:55], v[30:31]
    s_waitcnt vmcnt(10)
    v_lshlrev_b32 v40, 16, v64
    v_and_b32 v42, 0xffff0000, v64
    v_lshlrev_b32 v41, 16, v68
    v_and_b32 v43, 0xffff0000, v68
    v_lshlrev_b32 v44, 16, v65
    v_and_b32 v62, 0xffff0000, v65
    v_lshlrev_b32 v45, 16, v69
    v_and_b32 v63, 0xffff0000, v69
    v_lshlrev_b32 v64, 16, v66
    v_and_b32 v68, 0xffff0000, v66
    v_lshlrev_b32 v65, 16, v70
    v_and_b32 v69, 0xffff0000, v70
    v_lshlrev_b32 v66, 16, v67
    v_and_b32 v70, 0xffff0000, v67
    v_lshlrev_b32 v67, 16, v71
    v_and_b32 v71, 0xffff0000, v71
    s_barrier
    ds_read_b32 v7, v4 offset:64256
    ds_read2st64_b32 v[58:59], v47 offset0:28 offset1:29
    ds_read2st64_b32 v[60:61], v47 offset0:30 offset1:31
    ds_read_b128 v[8:11], v46 offset:57344
    ds_read_b128 v[12:15], v46 offset:58368
    ds_read_b128 v[16:19], v46 offset:59392
    ds_read_b128 v[20:23], v46 offset:60416
    ds_read_b128 v[24:27], v46 offset:61440
    ds_read_b128 v[28:31], v46 offset:62464
    ds_read_b128 v[32:35], v46 offset:63488
    ds_read_b128 v[36:39], v46 offset:64512
    s_waitcnt lgkmcnt(8)
    v_pk_add_f32 v[58:59], v[58:59], v[60:61]
    v_pk_add_f32 v[56:57], v[56:57], v[58:59]
    v_add_f32 v56, v56, v57
    v_lshlrev_b32 v7, 31, v7
    v_or_b32 v7, v7, v56
    v_subrev_u32 v7, s59, v7
    v_rcp_f32 v56, v56
    v_cmp_le_u32 vcc, s60, v7
    s_waitcnt lgkmcnt(6)
    v_pk_add_f32 v[48:49], v[48:49], v[8:9]
    v_pk_add_f32 v[50:51], v[50:51], v[10:11]
    v_pk_add_f32 v[52:53], v[52:53], v[12:13]
    v_pk_add_f32 v[54:55], v[54:55], v[14:15]
    v_mul_f32 v56, v5, v56
    s_cbranch_vccnz BADL
    s_waitcnt lgkmcnt(4)
    v_pk_add_f32 v[48:49], v[48:49], v[16:17]
    v_pk_add_f32 v[50:51], v[50:51], v[18:19]
    v_pk_add_f32 v[52:53], v[52:53], v[20:21]
    v_pk_add_f32 v[54:55], v[54:55], v[22:23]
    s_waitcnt lgkmcnt(2)
    v_pk_add_f32 v[48:49], v[48:49], v[24:25]
    v_pk_add_f32 v[50:51], v[50:51], v[26:27]
    v_pk_add_f32 v[52:53], v[52:53], v[28:29]
    v_pk_add_f32 v[54:55], v[54:55], v[30:31]
    s_waitcnt lgkmcnt(0)
    v_pk_add_f32 v[48:49], v[48:49], v[32:33]
    v_pk_add_f32 v[50:51], v[50:51], v[34:35]
    v_pk_add_f32 v[52:53], v[52:53], v[36:37]
    v_pk_add_f32 v[54:55], v[54:55], v[38:39]
    v_pk_mul_f32 v[48:49], v[48:49], v[56:57] op_sel_hi:[1,0]
    v_pk_mul_f32 v[50:51], v[50:51], v[56:57] op_sel_hi:[1,0]
    v_pk_mul_f32 v[52:53], v[52:53], v[56:57] op_sel_hi:[1,0]
    v_pk_mul_f32 v[54:55], v[54:55], v[56:57] op_sel_hi:[1,0]
    v_cvt_pk_bf16_f32 v24, v48, v49
    v_cvt_pk_bf16_f32 v25, v50, v51
    v_cvt_pk_bf16_f32 v26, v52, v53
    v_cvt_pk_bf16_f32 v27, v54, v55
    s_nop 1
    v_smfmac_f32_16x16x64_bf16 v[156:159], v[24:27], v[112:119], v2
    v_smfmac_f32_16x16x64_bf16 v[160:163], v[24:27], v[120:127], v2
    v_smfmac_f32_16x16x64_bf16 v[164:167], v[24:27], v[128:135], v2
    s_waitcnt vmcnt(0)
    v_smfmac_f32_16x16x64_bf16 v[136:139], v[24:27], v[72:79], v2
    s_nop 3
    v_permlane32_swap_b32 v156, v158
    v_permlane32_swap_b32 v157, v159
    v_pk_add_f32 v[156:157], v[156:157], v[158:159]
    v_pk_add_f32 v[156:157], v[156:157], v[68:69]
    v_smfmac_f32_16x16x64_bf16 v[140:143], v[24:27], v[80:87], v2
    v_permlane32_swap_b32 v160, v162
    v_permlane32_swap_b32 v161, v163
    v_pk_add_f32 v[160:161], v[160:161], v[162:163]
    v_pk_add_f32 v[160:161], v[160:161], v[66:67]
    v_smfmac_f32_16x16x64_bf16 v[144:147], v[24:27], v[88:95], v2
    v_permlane32_swap_b32 v164, v166
    v_permlane32_swap_b32 v165, v167
    v_pk_add_f32 v[164:165], v[164:165], v[166:167]
    v_pk_add_f32 v[164:165], v[164:165], v[70:71]
    v_smfmac_f32_16x16x64_bf16 v[148:151], v[24:27], v[96:103], v2
    v_permlane32_swap_b32 v136, v138
    v_permlane32_swap_b32 v137, v139
    v_pk_add_f32 v[136:137], v[136:137], v[138:139]
    v_pk_add_f32 v[136:137], v[136:137], v[40:41]
    v_smfmac_f32_16x16x64_bf16 v[152:155], v[24:27], v[104:111], v2
    v_permlane32_swap_b32 v140, v142
    v_permlane32_swap_b32 v141, v143
    v_pk_add_f32 v[140:141], v[140:141], v[142:143]
    v_pk_add_f32 v[140:141], v[140:141], v[42:43]
    v_permlane32_swap_b32 v144, v146
    v_permlane32_swap_b32 v145, v147
    v_pk_add_f32 v[144:145], v[144:145], v[146:147]
    v_pk_add_f32 v[144:145], v[144:145], v[44:45]
    v_permlane32_swap_b32 v148, v150
    v_permlane32_swap_b32 v149, v151
    v_pk_add_f32 v[148:149], v[148:149], v[150:151]
    v_pk_add_f32 v[148:149], v[148:149], v[62:63]
    v_permlane32_swap_b32 v152, v154
    v_permlane32_swap_b32 v153, v155
    v_pk_add_f32 v[152:153], v[152:153], v[154:155]
    v_pk_add_f32 v[152:153], v[152:153], v[64:65]
    v_cvt_pk_bf16_f32 v8, v136, v140
    v_cvt_pk_bf16_f32 v9, v144, v148
    v_cvt_pk_bf16_f32 v10, v152, v156
    v_cvt_pk_bf16_f32 v11, v160, v164
    buffer_store_dwordx4 v[8:11], v1, s[32:35], s65 offen offset:0 sc1
    v_cvt_pk_bf16_f32 v12, v137, v141
    v_cvt_pk_bf16_f32 v13, v145, v149
    v_cvt_pk_bf16_f32 v14, v153, v157
    v_cvt_pk_bf16_f32 v15, v161, v165
    buffer_store_dwordx4 v[12:15], v1, s[32:35], s65 offen offset:1024 sc1
    s_barrier
    s_endpgm
A1:
AG:
    ds_read_b32 v8, v4 offset:59136
    s_waitcnt lgkmcnt(0)
    v_cmp_gt_u32 vcc, 0x37774, v8
    s_cbranch_vccz AG_G
    s_add_u32 s67, s67, 1
    s_cmp_gt_u32 s67, 0x100000
    s_cbranch_scc1 END
    s_sleep 6
    s_branch AG
AG_G:
    v_and_b32 v7, 31, v1
    v_lshlrev_b32 v7, 2, v7
    buffer_load_dword v6, v7, s[28:31], s18 offen sc1
    v_cmp_lt_u32 vcc, 60, v7
    v_lshrrev_b32 v8, 5, v1
    v_and_b32 v9, 15, v1
    v_lshl_add_u32 v9, v8, 5, v9
    v_lshlrev_b32 v9, 3, v9
    v_lshlrev_b32 v8, 5, v8
    v_add_u32 v8, 1024, v8
    v_cndmask_b32 v12, v9, v8, vcc
    v_mov_b32 v10, 512
    v_mov_b32 v11, 128
    v_cndmask_b32 v10, v10, 8, vcc
    v_cndmask_b32 v11, v11, 16, vcc
    v_add_u32 v13, v12, v10
    v_add_u32 v14, v12, v11
    v_add_u32 v15, v13, v11
    s_lshl_b32 s3, s44, 11
    v_add_u32 v7, s3, v0
    ds_read_b128 v[48:51], v7 offset:21504
    ds_read_b128 v[52:55], v7 offset:22528
    s_mov_b32 s11, 0x358637bd
    s_mov_b32 s67, 0
POLLKV:
    buffer_load_dwordx2 v[40:41], v12, s[28:31], s17 offen sc1
    buffer_load_dwordx2 v[42:43], v13, s[28:31], s17 offen sc1
    buffer_load_dwordx2 v[44:45], v14, s[28:31], s17 offen sc1
    buffer_load_dwordx2 v[46:47], v15, s[28:31], s17 offen sc1
    s_waitcnt vmcnt(0) lgkmcnt(0)
    v_max3_u32 v8, v40, v41, v42
    v_max3_u32 v8, v8, v43, v44
    v_max3_u32 v8, v8, v45, v46
    v_max_u32 v8, v8, v47
    v_cmp_eq_u32 vcc, -1, v8
    s_cbranch_vccz GOTKV
    s_add_u32 s67, s67, 1
    s_cmp_gt_u32 s67, 0x8000
    s_cbranch_scc1 GOTKV
    s_sleep 8
    s_branch POLLKV
GOTKV:
    v_mfma_f32_32x32x16_bf16 v[8:23], v[40:43], v[48:51], 0
    v_mfma_f32_32x32x16_bf16 v[24:39], v[44:47], v[52:55], 0
    s_nop 10
    v_add_f32 v16, s11, v16
    v_rcp_f32 v16, v16
    s_nop 0
    v_mul_f32 v16, v6, v16
    v_pk_mul_f32 v[8:9], v[8:9], v[16:17] op_sel_hi:[1,0]
    v_pk_mul_f32 v[10:11], v[10:11], v[16:17] op_sel_hi:[1,0]
    v_pk_mul_f32 v[12:13], v[12:13], v[16:17] op_sel_hi:[1,0]
    v_pk_mul_f32 v[14:15], v[14:15], v[16:17] op_sel_hi:[1,0]
    v_cvt_pk_bf16_f32 v20, v8, v9
    v_cvt_pk_bf16_f32 v21, v10, v11
    v_cvt_pk_bf16_f32 v22, v12, v13
    v_cvt_pk_bf16_f32 v23, v14, v15
    buffer_store_dwordx4 v[20:23], v0, s[28:31], s16 offen offset:0 sc1
    v_add_f32 v32, s11, v32
    v_rcp_f32 v32, v32
    s_nop 0
    v_mul_f32 v32, v6, v32
    v_pk_mul_f32 v[24:25], v[24:25], v[32:33] op_sel_hi:[1,0]
    v_pk_mul_f32 v[26:27], v[26:27], v[32:33] op_sel_hi:[1,0]
    v_pk_mul_f32 v[28:29], v[28:29], v[32:33] op_sel_hi:[1,0]
    v_pk_mul_f32 v[30:31], v[30:31], v[32:33] op_sel_hi:[1,0]
    v_cvt_pk_bf16_f32 v36, v24, v25
    v_cvt_pk_bf16_f32 v37, v26, v27
    v_cvt_pk_bf16_f32 v38, v28, v29
    v_cvt_pk_bf16_f32 v39, v30, v31
    buffer_store_dwordx4 v[36:39], v0, s[28:31], s16 offen offset:1024 sc1
    v_mov_b32 v6, 1
    v_mov_b32 v9, s57
    s_waitcnt vmcnt(0)
    ds_add_rtn_u32 v8, v4, v6 offset:63488
    s_waitcnt lgkmcnt(0)
    v_cmp_ne_u32 vcc, 3, v8
    s_cbranch_vccnz GP2
    s_mov_b32 exec_hi, 0
    buffer_store_dword v9, v4, s[28:31], s66 offen sc1
    s_mov_b64 exec, -1
GP2:
    s_cmp_eq_u32 s44, 0
    s_cbranch_scc0 ER0
EW0:
    ds_read_b32 v8, v4 offset:58368
    s_waitcnt lgkmcnt(0)
    v_cmp_ne_u32 vcc, s58, v8
    s_cbranch_vccz EW0_G
    s_add_u32 s67, s67, 1
    s_cmp_gt_u32 s67, 0x100000
    s_cbranch_scc1 END
    s_sleep 2
    s_branch EW0
EW0_G:
    s_branch DUTY
ER0:
PG:
    ds_read_b32 v8, v4 offset:58624
    s_waitcnt lgkmcnt(0)
    v_cmp_gt_u32 vcc, 0x45551, v8
    s_cbranch_vccz PG_G
    s_add_u32 s67, s67, 1
    s_cmp_gt_u32 s67, 0x100000
    s_cbranch_scc1 END
    s_sleep 4
    s_branch PG
PG_G:
GCW:
    ds_read_b32 v8, v4 offset:63488
    s_waitcnt lgkmcnt(0)
    v_cmp_ne_u32 vcc, 4, v8
    s_cbranch_vccz GCW_G
    s_add_u32 s67, s67, 1
    s_cmp_gt_u32 s67, 0x100000
    s_cbranch_scc1 END
    s_sleep 2
    s_branch GCW
GCW_G:
    v_and_b32 v7, 7, v1
    v_lshl_add_u32 v7, v7, 12, s19
    s_lshl_b32 s13, s47, 15
    s_lshl_b32 s12, s44, 13
    s_add_u32 s10, s13, s12
    s_add_u32 s10, s10, 0x200000
    s_add_u32 m0, s12, 21504
PPW:
    buffer_load_dword v8, v7, s[28:31], 0 offen sc1
    s_waitcnt vmcnt(0)
    v_cmp_ne_u32 vcc, s57, v8
    s_cbranch_vccz PPW_G
    s_mov_b64 exec, vcc
    s_add_u32 s67, s67, 1
    s_cmp_gt_u32 s67, 0x100000
    s_cbranch_scc1 END
    s_sleep 8
    s_branch PPW
PPW_G:
    s_mov_b64 exec, -1
    buffer_load_dwordx4 v0, s[28:31], s10 offen offset:0 sc1 lds
    buffer_load_dwordx4 v0, s[28:31], s10 offen offset:1024 sc1 lds
    buffer_load_dwordx4 v0, s[28:31], s10 offen offset:2048 sc1 lds
    buffer_load_dwordx4 v0, s[28:31], s10 offen offset:3072 sc1 lds
    s_add_u32 s10, s10, 4096
    s_add_u32 m0, m0, 4096
    s_nop 0
    buffer_load_dwordx4 v0, s[28:31], s10 offen offset:0 sc1 lds
    buffer_load_dwordx4 v0, s[28:31], s10 offen offset:1024 sc1 lds
    buffer_load_dwordx4 v0, s[28:31], s10 offen offset:2048 sc1 lds
    buffer_load_dwordx4 v0, s[28:31], s10 offen offset:3072 sc1 lds
    v_mov_b32 v6, 1
    s_waitcnt vmcnt(0)
    ds_add_u32 v4, v6 offset:62464
    s_cmp_eq_u32 s44, 1
    s_cbranch_scc0 ER1
EW1:
    ds_read_b32 v8, v4 offset:58624
    s_waitcnt lgkmcnt(0)
    v_cmp_ne_u32 vcc, s58, v8
    s_cbranch_vccz EW1_G
    s_add_u32 s67, s67, 1
    s_cmp_gt_u32 s67, 0x100000
    s_cbranch_scc1 END
    s_sleep 2
    s_branch EW1
EW1_G:
    s_branch DUTY
ER1:
    s_cmp_eq_u32 s44, 2
    s_cbranch_scc0 ER2
EW2:
    ds_read_b32 v8, v4 offset:58880
    s_waitcnt lgkmcnt(0)
    v_cmp_ne_u32 vcc, s58, v8
    s_cbranch_vccz EW2_G
    s_add_u32 s67, s67, 1
    s_cmp_gt_u32 s67, 0x100000
    s_cbranch_scc1 END
    s_sleep 2
    s_branch EW2
EW2_G:
    s_branch DUTY
ER2:
POLLOA:
    ds_read_b32 v8, v4 offset:62464
    s_waitcnt lgkmcnt(0)
    v_cmp_gt_u32 vcc, 4, v8
    s_cbranch_vccz POLLOA_G
    s_add_u32 s67, s67, 1
    s_cmp_gt_u32 s67, 0x100000
    s_cbranch_scc1 END
    s_sleep 2
    s_branch POLLOA
POLLOA_G:
    s_add_u32 s3, s55, 0x4000
    s_lshl_b32 s11, s46, 2
    s_add_u32 s11, s11, s44
    s_lshl_b32 s11, s11, 7
    s_add_u32 s11, s11, 0x4d0000
    s_add_u32 s63, s44, 1
    s_and_b32 s63, s63, 3
    ds_read_b128 v[152:155], v0 offset:21504
    s_waitcnt lgkmcnt(0)
    v_mfma_f32_32x32x16_bf16 v[136:151], v[72:75], v[152:155], 0
    buffer_load_dwordx4 v[72:75], v0, s[28:31], s3 offen offset:0 sc1
    ds_read_b128 v[156:159], v0 offset:22528
    s_waitcnt lgkmcnt(0)
    v_mfma_f32_32x32x16_bf16 v[136:151], v[76:79], v[156:159], v[136:151]
    buffer_load_dwordx4 v[76:79], v0, s[28:31], s3 offen offset:1024 sc1
    ds_read_b128 v[160:163], v0 offset:23552
    s_waitcnt lgkmcnt(0)
    v_mfma_f32_32x32x16_bf16 v[136:151], v[80:83], v[160:163], v[136:151]
    buffer_load_dwordx4 v[80:83], v0, s[28:31], s3 offen offset:2048 sc1
    ds_read_b128 v[164:167], v0 offset:24576
    s_waitcnt lgkmcnt(0)
    v_mfma_f32_32x32x16_bf16 v[136:151], v[84:87], v[164:167], v[136:151]
    buffer_load_dwordx4 v[84:87], v0, s[28:31], s3 offen offset:3072 sc1
    s_add_u32 s3, s3, 4096
    ds_read_b128 v[152:155], v0 offset:25600
    s_waitcnt lgkmcnt(0)
    v_mfma_f32_32x32x16_bf16 v[136:151], v[88:91], v[152:155], v[136:151]
    buffer_load_dwordx4 v[88:91], v0, s[28:31], s3 offen offset:0 sc1
    ds_read_b128 v[156:159], v0 offset:26624
    s_waitcnt lgkmcnt(0)
    v_mfma_f32_32x32x16_bf16 v[136:151], v[92:95], v[156:159], v[136:151]
    buffer_load_dwordx4 v[92:95], v0, s[28:31], s3 offen offset:1024 sc1
    ds_read_b128 v[160:163], v0 offset:27648
    s_waitcnt lgkmcnt(0)
    v_mfma_f32_32x32x16_bf16 v[136:151], v[96:99], v[160:163], v[136:151]
    buffer_load_dwordx4 v[96:99], v0, s[28:31], s3 offen offset:2048 sc1
    s_cmp_lt_u32 s44, 3
    s_cbranch_scc0 NOFB
    v_mov_b32 v9, s57
    s_waitcnt vmcnt(7)
    s_mov_b32 exec_hi, 0
    buffer_store_dword v9, v4, s[28:31], s11 offen sc1
    s_mov_b64 exec, -1
NOFB:
    ds_read_b128 v[164:167], v0 offset:28672
    s_waitcnt lgkmcnt(0)
    v_mfma_f32_32x32x16_bf16 v[136:151], v[100:103], v[164:167], v[136:151]
    buffer_load_dwordx4 v[100:103], v0, s[28:31], s3 offen offset:3072 sc1
    s_add_u32 s3, s3, 4096
    ds_read_b128 v[152:155], v0 offset:29696
    s_waitcnt lgkmcnt(0)
    v_mfma_f32_32x32x16_bf16 v[136:151], v[104:107], v[152:155], v[136:151]
    buffer_load_dwordx4 v[104:107], v0, s[28:31], s3 offen offset:0 sc1
    s_mov_b32 s12, s3
    s_cmp_eq_u32 s44, 3
    s_cbranch_scc0 ER3
EW3:
    ds_read_b32 v8, v4 offset:59136
    s_waitcnt lgkmcnt(0)
    v_cmp_ne_u32 vcc, s58, v8
    s_cbranch_vccz EW3_G
    s_add_u32 s67, s67, 1
    s_cmp_gt_u32 s67, 0x100000
    s_cbranch_scc1 END
    s_sleep 2
    s_branch EW3
EW3_G:
    s_branch DUTY
ER3:
    s_mov_b32 s3, s12
    ds_read_b128 v[156:159], v0 offset:30720
    s_waitcnt lgkmcnt(0)
    v_mfma_f32_32x32x16_bf16 v[136:151], v[108:111], v[156:159], v[136:151]
    buffer_load_dwordx4 v[108:111], v0, s[28:31], s3 offen offset:1024 sc1
    ds_read_b128 v[160:163], v0 offset:31744
    s_waitcnt lgkmcnt(0)
    v_mfma_f32_32x32x16_bf16 v[136:151], v[112:115], v[160:163], v[136:151]
    buffer_load_dwordx4 v[112:115], v0, s[28:31], s3 offen offset:2048 sc1
    ds_read_b128 v[164:167], v0 offset:32768
    s_waitcnt lgkmcnt(0)
    v_mfma_f32_32x32x16_bf16 v[136:151], v[116:119], v[164:167], v[136:151]
    buffer_load_dwordx4 v[116:119], v0, s[28:31], s3 offen offset:3072 sc1
    s_add_u32 s3, s3, 4096
    ds_read_b128 v[152:155], v0 offset:33792
    s_waitcnt lgkmcnt(0)
    v_mfma_f32_32x32x16_bf16 v[136:151], v[120:123], v[152:155], v[136:151]
    buffer_load_dwordx4 v[120:123], v0, s[28:31], s3 offen offset:0 sc1
    ds_read_b128 v[156:159], v0 offset:34816
    s_waitcnt lgkmcnt(0)
    v_mfma_f32_32x32x16_bf16 v[136:151], v[124:127], v[156:159], v[136:151]
    buffer_load_dwordx4 v[124:127], v0, s[28:31], s3 offen offset:1024 sc1
    ds_read_b128 v[160:163], v0 offset:35840
    s_waitcnt lgkmcnt(0)
    v_mfma_f32_32x32x16_bf16 v[136:151], v[128:131], v[160:163], v[136:151]
    buffer_load_dwordx4 v[128:131], v0, s[28:31], s3 offen offset:2048 sc1
    ds_read_b128 v[164:167], v0 offset:36864
    s_waitcnt lgkmcnt(0)
    v_mfma_f32_32x32x16_bf16 v[136:151], v[132:135], v[164:167], v[136:151]
    buffer_load_dwordx4 v[132:135], v0, s[28:31], s3 offen offset:3072 sc1
    s_add_u32 s3, s3, 4096
    s_cmp_eq_u32 s44, 3
    s_cbranch_scc0 NOF3
    v_mov_b32 v9, s57
    s_waitcnt vmcnt(7)
    s_mov_b32 exec_hi, 0
    buffer_store_dword v9, v4, s[28:31], s11 offen sc1
    s_mov_b64 exec, -1
NOF3:
    ds_read_b128 v[152:155], v0 offset:37888
    s_waitcnt vmcnt(15) lgkmcnt(0)
    v_mfma_f32_32x32x16_bf16 v[136:151], v[72:75], v[152:155], v[136:151]
    s_add_u32 s3, s55, 0x200000
    buffer_load_dwordx4 v[72:75], v0, s[28:31], s3 offen offset:0 sc1
    ds_read_b128 v[156:159], v0 offset:38912
    s_waitcnt vmcnt(15) lgkmcnt(0)
    v_mfma_f32_32x32x16_bf16 v[136:151], v[76:79], v[156:159], v[136:151]
    buffer_load_dwordx4 v[76:79], v0, s[28:31], s3 offen offset:1024 sc1
    ds_read_b128 v[160:163], v0 offset:39936
    s_waitcnt vmcnt(15) lgkmcnt(0)
    v_mfma_f32_32x32x16_bf16 v[136:151], v[80:83], v[160:163], v[136:151]
    buffer_load_dwordx4 v[80:83], v0, s[28:31], s3 offen offset:2048 sc1
    ds_read_b128 v[164:167], v0 offset:40960
    s_waitcnt vmcnt(15) lgkmcnt(0)
    v_mfma_f32_32x32x16_bf16 v[136:151], v[84:87], v[164:167], v[136:151]
    buffer_load_dwordx4 v[84:87], v0, s[28:31], s3 offen offset:3072 sc1
    s_add_u32 s3, s3, 4096
    ds_read_b128 v[152:155], v0 offset:41984
    s_waitcnt vmcnt(15) lgkmcnt(0)
    v_mfma_f32_32x32x16_bf16 v[136:151], v[88:91], v[152:155], v[136:151]
    buffer_load_dwordx4 v[88:91], v0, s[28:31], s3 offen offset:0 sc1
    ds_read_b128 v[156:159], v0 offset:43008
    s_waitcnt vmcnt(15) lgkmcnt(0)
    v_mfma_f32_32x32x16_bf16 v[136:151], v[92:95], v[156:159], v[136:151]
    buffer_load_dwordx4 v[92:95], v0, s[28:31], s3 offen offset:1024 sc1
    ds_read_b128 v[160:163], v0 offset:44032
    s_waitcnt vmcnt(15) lgkmcnt(0)
    v_mfma_f32_32x32x16_bf16 v[136:151], v[96:99], v[160:163], v[136:151]
    buffer_load_dwordx4 v[96:99], v0, s[28:31], s3 offen offset:2048 sc1
    ds_read_b128 v[164:167], v0 offset:45056
    s_waitcnt vmcnt(15) lgkmcnt(0)
    v_mfma_f32_32x32x16_bf16 v[136:151], v[100:103], v[164:167], v[136:151]
    buffer_load_dwordx4 v[100:103], v0, s[28:31], s3 offen offset:3072 sc1
    s_add_u32 s3, s3, 4096
    ds_read_b128 v[152:155], v0 offset:46080
    s_waitcnt vmcnt(15) lgkmcnt(0)
    v_mfma_f32_32x32x16_bf16 v[136:151], v[104:107], v[152:155], v[136:151]
    buffer_load_dwordx4 v[104:107], v0, s[28:31], s3 offen offset:0 sc1
    ds_read_b128 v[156:159], v0 offset:47104
    s_waitcnt vmcnt(15) lgkmcnt(0)
    v_mfma_f32_32x32x16_bf16 v[136:151], v[108:111], v[156:159], v[136:151]
    buffer_load_dwordx4 v[108:111], v0, s[28:31], s3 offen offset:1024 sc1
    ds_read_b128 v[160:163], v0 offset:48128
    s_waitcnt vmcnt(15) lgkmcnt(0)
    v_mfma_f32_32x32x16_bf16 v[136:151], v[112:115], v[160:163], v[136:151]
    buffer_load_dwordx4 v[112:115], v0, s[28:31], s3 offen offset:2048 sc1
    s_cmp_lt_u32 s63, 4
    s_cbranch_scc0 NOL0
    s_lshl_b32 s12, s47, 4
    s_add_u32 s12, s12, s63
    s_lshl_b32 s12, s12, 7
    s_add_u32 s12, s12, 0x4d0000
    v_and_b32 v7, 3, v1
    v_lshl_add_u32 v7, v7, 9, s12
    s_lshl_b32 s10, s63, 12
    s_add_u32 s10, s10, s13
    s_add_u32 s10, s10, 0xe00000
    s_mov_b32 s12, 159744
    s_cmp_eq_u32 s63, 1
    s_cselect_b32 s12, 10240, s12
    s_cmp_eq_u32 s63, 2
    s_cselect_b32 s12, 54272, s12
    s_cmp_eq_u32 s63, 3
    s_cselect_b32 s12, 155648, s12
    s_mov_b32 m0, s12
    buffer_load_dword v8, v7, s[28:31], 0 offen sc1
    ds_read_b32 v10, v4 offset:60672
NOL0:
    ds_read_b128 v[164:167], v0 offset:49152
    s_waitcnt vmcnt(15) lgkmcnt(0)
    v_mfma_f32_32x32x16_bf16 v[136:151], v[116:119], v[164:167], v[136:151]
    buffer_load_dwordx4 v[116:119], v0, s[28:31], s3 offen offset:3072 sc1
    s_add_u32 s3, s3, 4096
    ds_read_b128 v[152:155], v0 offset:50176
    s_waitcnt vmcnt(15) lgkmcnt(0)
    v_mfma_f32_32x32x16_bf16 v[136:151], v[120:123], v[152:155], v[136:151]
    buffer_load_dwordx4 v[120:123], v0, s[28:31], s3 offen offset:0 sc1
    ds_read_b128 v[156:159], v0 offset:51200
    s_waitcnt vmcnt(15) lgkmcnt(0)
    v_mfma_f32_32x32x16_bf16 v[136:151], v[124:127], v[156:159], v[136:151]
    buffer_load_dwordx4 v[124:127], v0, s[28:31], s3 offen offset:1024 sc1
    ds_read_b128 v[160:163], v0 offset:52224
    s_waitcnt vmcnt(15) lgkmcnt(0)
    v_mfma_f32_32x32x16_bf16 v[136:151], v[128:131], v[160:163], v[136:151]
    buffer_load_dwordx4 v[128:131], v0, s[28:31], s3 offen offset:2048 sc1
    ds_read_b128 v[164:167], v0 offset:53248
    s_waitcnt vmcnt(15) lgkmcnt(0)
    v_mfma_f32_32x32x16_bf16 v[136:151], v[132:135], v[164:167], v[136:151]
    buffer_load_dwordx4 v[132:135], v0, s[28:31], s3 offen offset:3072 sc1
    s_add_u32 s3, s3, 4096
    s_cmp_lt_u32 s63, 4
    s_cbranch_scc0 NOL
    s_waitcnt vmcnt(5)
    v_cmp_ne_u32 vcc, s57, v8
    s_cbranch_vccnz NOL
    v_cmp_ne_u32 vcc, 1, v10
    s_cbranch_vccnz NOL
    buffer_load_dwordx4 v0, s[28:31], s10 offen offset:0 sc1 lds
    buffer_load_dwordx4 v0, s[28:31], s10 offen offset:1024 sc1 lds
    buffer_load_dwordx4 v0, s[28:31], s10 offen offset:2048 sc1 lds
    buffer_load_dwordx4 v0, s[28:31], s10 offen offset:3072 sc1 lds
    s_add_u32 s63, s63, 4
NOL:
    s_cmp_lt_u32 s63, 4
    s_cbranch_scc0 NOB1
FFW:
    ds_read_b32 v8, v4 offset:60672
    s_waitcnt lgkmcnt(0)
    v_cmp_ne_u32 vcc, 1, v8
    s_cbranch_vccz FFW_G
    s_add_u32 s67, s67, 1
    s_cmp_gt_u32 s67, 0x100000
    s_cbranch_scc1 END
    s_sleep 2
    s_branch FFW
FFW_G:
FBW:
    buffer_load_dword v8, v7, s[28:31], 0 offen sc1
    s_waitcnt vmcnt(0)
    v_cmp_ne_u32 vcc, s57, v8
    s_cbranch_vccz FBW_G
    s_mov_b64 exec, vcc
    s_add_u32 s67, s67, 1
    s_cmp_gt_u32 s67, 0x100000
    s_cbranch_scc1 END
    s_sleep 8
    s_branch FBW
FBW_G:
    s_mov_b64 exec, -1
    buffer_load_dwordx4 v0, s[28:31], s10 offen offset:0 sc1 lds
    buffer_load_dwordx4 v0, s[28:31], s10 offen offset:1024 sc1 lds
    buffer_load_dwordx4 v0, s[28:31], s10 offen offset:2048 sc1 lds
    buffer_load_dwordx4 v0, s[28:31], s10 offen offset:3072 sc1 lds
    s_add_u32 s63, s63, 4
NOB1:
    s_cmp_ge_u32 s63, 4
    s_cbranch_scc0 NOBD
    s_waitcnt vmcnt(0)
    ds_add_u32 v4, v6 offset:62464
NOBD:
    s_mov_b32 s62, 1
POLLOB:
    s_lshl_b32 m0, s56, 8
    ds_read_b32 v9, v4 offset:62464
    ds_read_addtid_b32 v8 offset:58368
    s_waitcnt lgkmcnt(0)
    v_cmp_ne_u32 vcc, s58, v8
    s_cbranch_vccz DUTY
    v_cmp_ne_u32 vcc, 8, v9
    s_cbranch_vccz POLLOB_G
    s_add_u32 s67, s67, 1
    s_cmp_gt_u32 s67, 0x100000
    s_cbranch_scc1 END
    s_sleep 2
    s_branch POLLOB
POLLOB_G:
    s_mov_b32 s3, s54
    s_add_u32 s54, s54, 0x10000
    s_waitcnt vmcnt(0)
    v_add_u32 v7, 155648, v0
    ds_read_b128 v[152:155], v7 offset:4096
    s_waitcnt lgkmcnt(0)
    v_mfma_f32_32x32x16_bf16 v[136:151], v[72:75], v[152:155], v[136:151]
    buffer_load_dwordx4 v[72:75], v0, s[28:31], s3 offen offset:0 sc1
    ds_read_b128 v[156:159], v7 offset:5120
    s_waitcnt lgkmcnt(0)
    v_mfma_f32_32x32x16_bf16 v[136:151], v[76:79], v[156:159], v[136:151]
    buffer_load_dwordx4 v[76:79], v0, s[28:31], s3 offen offset:1024 sc1
    ds_read_b128 v[160:163], v7 offset:6144
    s_waitcnt lgkmcnt(0)
    v_mfma_f32_32x32x16_bf16 v[136:151], v[80:83], v[160:163], v[136:151]
    buffer_load_dwordx4 v[80:83], v0, s[28:31], s3 offen offset:2048 sc1
    ds_read_b128 v[164:167], v7 offset:7168
    s_waitcnt lgkmcnt(0)
    v_mfma_f32_32x32x16_bf16 v[136:151], v[84:87], v[164:167], v[136:151]
    buffer_load_dwordx4 v[84:87], v0, s[28:31], s3 offen offset:3072 sc1
    s_add_u32 s3, s3, 4096
    ds_read_b128 v[152:155], v0 offset:10240
    s_waitcnt lgkmcnt(0)
    v_mfma_f32_32x32x16_bf16 v[136:151], v[88:91], v[152:155], v[136:151]
    buffer_load_dwordx4 v[88:91], v0, s[28:31], s3 offen offset:0 sc1
    ds_read_b128 v[156:159], v0 offset:11264
    s_waitcnt lgkmcnt(0)
    v_mfma_f32_32x32x16_bf16 v[136:151], v[92:95], v[156:159], v[136:151]
    buffer_load_dwordx4 v[92:95], v0, s[28:31], s3 offen offset:1024 sc1
    ds_read_b128 v[160:163], v0 offset:12288
    s_waitcnt lgkmcnt(0)
    v_mfma_f32_32x32x16_bf16 v[136:151], v[96:99], v[160:163], v[136:151]
    buffer_load_dwordx4 v[96:99], v0, s[28:31], s3 offen offset:2048 sc1
    ds_read_b128 v[164:167], v0 offset:13312
    s_waitcnt lgkmcnt(0)
    v_mfma_f32_32x32x16_bf16 v[136:151], v[100:103], v[164:167], v[136:151]
    buffer_load_dwordx4 v[100:103], v0, s[28:31], s3 offen offset:3072 sc1
    s_add_u32 s3, s3, 4096
    ds_read_b128 v[152:155], v0 offset:54272
    s_waitcnt lgkmcnt(0)
    v_mfma_f32_32x32x16_bf16 v[136:151], v[104:107], v[152:155], v[136:151]
    buffer_load_dwordx4 v[104:107], v0, s[28:31], s3 offen offset:0 sc1
    ds_read_b128 v[156:159], v0 offset:55296
    s_waitcnt lgkmcnt(0)
    v_mfma_f32_32x32x16_bf16 v[136:151], v[108:111], v[156:159], v[136:151]
    buffer_load_dwordx4 v[108:111], v0, s[28:31], s3 offen offset:1024 sc1
    ds_read_b128 v[160:163], v0 offset:56320
    s_waitcnt lgkmcnt(0)
    v_mfma_f32_32x32x16_bf16 v[136:151], v[112:115], v[160:163], v[136:151]
    buffer_load_dwordx4 v[112:115], v0, s[28:31], s3 offen offset:2048 sc1
    ds_read_b128 v[164:167], v0 offset:57344
    s_waitcnt lgkmcnt(0)
    v_mfma_f32_32x32x16_bf16 v[136:151], v[116:119], v[164:167], v[136:151]
    buffer_load_dwordx4 v[116:119], v0, s[28:31], s3 offen offset:3072 sc1
    s_add_u32 s3, s3, 4096
    ds_read_b128 v[152:155], v7 offset:0
    s_waitcnt lgkmcnt(0)
    v_mfma_f32_32x32x16_bf16 v[136:151], v[120:123], v[152:155], v[136:151]
    buffer_load_dwordx4 v[120:123], v0, s[28:31], s3 offen offset:0 sc1
    ds_read_b128 v[156:159], v7 offset:1024
    s_waitcnt lgkmcnt(0)
    v_mfma_f32_32x32x16_bf16 v[136:151], v[124:127], v[156:159], v[136:151]
    buffer_load_dwordx4 v[124:127], v0, s[28:31], s3 offen offset:1024 sc1
    ds_read_b128 v[160:163], v7 offset:2048
    s_waitcnt lgkmcnt(0)
    v_mfma_f32_32x32x16_bf16 v[136:151], v[128:131], v[160:163], v[136:151]
    buffer_load_dwordx4 v[128:131], v0, s[28:31], s3 offen offset:2048 sc1
    ds_read_b128 v[164:167], v7 offset:3072
    s_waitcnt lgkmcnt(0)
    v_mfma_f32_32x32x16_bf16 v[136:151], v[132:135], v[164:167], v[136:151]
    buffer_load_dwordx4 v[132:135], v0, s[28:31], s3 offen offset:3072 sc1
    s_lshl_b32 s3, s46, 2
    s_add_u32 s3, s3, s44
    s_lshl_b32 s10, s3, 11
    s_add_u32 s10, s10, 0x800000
    s_nop 6
    v_cvt_pk_bf16_f32 v16, v136, v137
    v_cvt_pk_bf16_f32 v17, v138, v139
    v_cvt_pk_bf16_f32 v18, v140, v141
    v_cvt_pk_bf16_f32 v19, v142, v143
    buffer_store_dwordx4 v[16:19], v0, s[28:31], s10 offen offset:0 sc1
    v_cvt_pk_bf16_f32 v20, v144, v145
    v_cvt_pk_bf16_f32 v21, v146, v147
    v_cvt_pk_bf16_f32 v22, v148, v149
    v_cvt_pk_bf16_f32 v23, v150, v151
    buffer_store_dwordx4 v[20:23], v0, s[28:31], s10 offen offset:1024 sc1
    s_lshl_b32 s66, s3, 7
    s_add_u32 s66, s66, 0x480000
    s_mov_b32 s62, 2
    ds_read_b128 v[136:139], v0 offset:64512
    ds_read_b128 v[140:143], v0 offset:64512
    ds_read_b128 v[144:147], v0 offset:64512
    ds_read_b128 v[148:151], v0 offset:64512
    ds_read_b128 v[152:155], v0 offset:64512
    ds_read_b128 v[156:159], v0 offset:64512
    ds_read_b128 v[160:163], v0 offset:64512
    ds_read_b128 v[164:167], v0 offset:64512
    s_lshl_b32 s3, s2, 2
    s_add_u32 s3, s3, s44
    s_cmp_eq_u32 s3, 3
    s_cbranch_scc0 NOEP
    v_mov_b32 v24, s57
    s_mov_b32 s12, 0x47c000
    s_mov_b64 exec, 1
    buffer_store_dword v24, v0, s[28:31], s12 offen sc1
    s_mov_b64 exec, -1
NOEP:
    s_branch BLK
PUB:
    v_mov_b32 v9, s57
    v_lshlrev_b32 v7, 2, v1
    s_mov_b32 s62, 0
    s_waitcnt vmcnt(0)
    s_mov_b32 exec_hi, 0
    buffer_store_dword v9, v7, s[28:31], s66 offen sc1
    s_mov_b64 exec, -1
    s_branch BLK
PUBM:
    v_mov_b32 v9, s57
    v_lshlrev_b32 v7, 2, v1
    s_mov_b32 s62, 0
    s_waitcnt vmcnt(10)
    s_mov_b32 exec_hi, 0
    buffer_store_dword v9, v7, s[28:31], s66 offen sc1
    s_mov_b64 exec, -1
    s_branch PUBR
DUTX:
    ds_write_addtid_b32 v6 offset:60416
    s_cbranch_vccz DUTY0
    v_mov_b32 v16, 0
    v_mov_b32 v17, 0
    v_mov_b32 v18, 0
    v_mov_b32 v19, 0
    s_lshl_b32 s3, 1, s10
    v_mov_b32 v7, s3
    ds_or_b32 v4, v7 offset:63744
DUTY0:
    v_bfe_u32 v7, v1, 3, 2
    v_lshlrev_b32 v7, 10, v7
    v_and_b32 v8, 0x27, v1
    v_lshl_add_u32 v7, v8, 4, v7
    s_lshl_b32 s3, s10, 12
    s_add_u32 s3, s3, s52
    s_add_u32 s3, s3, 0xe00000
    buffer_store_dwordx4 v[16:19], v7, s[28:31], s3 offen sc1
    s_cmp_eq_u32 s10, 0
    s_cbranch_scc1 ER0
    s_cmp_eq_u32 s10, 1
    s_cbranch_scc1 ER1
    s_cmp_eq_u32 s10, 2
    s_cbranch_scc1 ER2
    s_branch ER3
BADL:
    ds_write_b32 v4, v6 offset:64256
    s_waitcnt lgkmcnt(0)
    s_barrier
    s_branch SLOWS
LAST:
    s_waitcnt vmcnt(0) lgkmcnt(0)
    s_barrier
    ds_read2st64_b32 v[32:33], v41 offset0:24 offset1:25
    ds_read2st64_b32 v[34:35], v41 offset0:26 offset1:27
    ds_read2st64_b32 v[36:37], v41 offset0:28 offset1:29
    ds_read2st64_b32 v[38:39], v41 offset0:30 offset1:31
    ds_read2st64_b64 v[8:11], v40 offset0:96 offset1:100
    ds_read2st64_b64 v[12:15], v40 offset0:104 offset1:108
    ds_read2st64_b64 v[16:19], v40 offset0:112 offset1:116
    ds_read2st64_b64 v[20:23], v40 offset0:120 offset1:124
    s_waitcnt lgkmcnt(4)
    v_pk_add_f32 v[32:33], v[32:33], v[34:35]
    v_pk_add_f32 v[36:37], v[36:37], v[38:39]
    v_pk_add_f32 v[32:33], v[32:33], v[36:37]
    v_add_f32 v32, v32, v33
    v_subrev_u32 v7, s59, v32
    v_rcp_f32 v32, v32
    v_cmp_le_u32 vcc, s60, v7
    s_waitcnt lgkmcnt(0)
    v_pk_add_f32 v[8:9], v[8:9], v[10:11]
    v_pk_add_f32 v[10:11], v[12:13], v[14:15]
    v_pk_add_f32 v[12:13], v[16:17], v[18:19]
    v_pk_add_f32 v[14:15], v[20:21], v[22:23]
    v_mul_f32 v32, v43, v32
    v_pk_add_f32 v[8:9], v[8:9], v[10:11]
    v_pk_add_f32 v[10:11], v[12:13], v[14:15]
    v_pk_add_f32 v[8:9], v[8:9], v[10:11]
    s_or_b64 s[50:51], s[50:51], vcc
    v_pk_mul_f32 v[8:9], v[8:9], v[32:33] op_sel_hi:[1,0]
    s_nop 0
    v_cvt_pk_bf16_f32 v8, v8, v9
    ds_write_b32 v42, v8 offset:1024
    s_waitcnt lgkmcnt(0)
    s_barrier
    ds_read_b128 v[24:27], v3
    s_waitcnt lgkmcnt(0)
    s_branch SLOWS2
SLOWS:
    v_lshrrev_b32 v1, 2, v4
    ds_read_b32 v7, v4 offset:63744
    s_waitcnt lgkmcnt(0)
    v_readfirstlane_b32 s53, v7
    s_nop 0
    s_or_b32 s53, s53, 0xf0
    s_and_b32 s10, s44, 1
    s_lshr_b32 s11, s44, 1
    s_lshl_b32 s3, s10, 10
    s_lshl_b32 s12, s11, 9
    s_add_u32 s3, s3, s12
    s_add_u32 s3, s3, 65536
    v_lshl_add_u32 v40, v1, 3, s3
    v_lshrrev_b32 v7, 1, v1
    s_lshl_b32 s3, s11, 7
    s_add_u32 s3, s3, 0
    v_lshl_add_u32 v41, v7, 2, s3
    v_lshlrev_b32 v6, 2, v7
    ds_bpermute_b32 v43, v6, v5
    s_lshl_b32 s3, s10, 3
    s_add_u32 s3, s3, s12
    s_add_u32 s3, s3, 18432
    v_lshl_add_u32 v42, v7, 4, s3
    v_and_b32 v7, 1, v1
    v_lshl_add_u32 v42, v7, 2, v42
    s_mov_b32 s49, -1
    v_mov_b32 v7, 0xff800000
    s_lshl_b32 m0, s44, 8
    s_nop 7
    ds_write_addtid_b32 v7 offset:21504
    v_pk_mov_b32 v[136:137], 0, 0
    v_pk_mov_b32 v[138:139], 0, 0
    v_pk_mov_b32 v[140:141], 0, 0
    v_pk_mov_b32 v[142:143], 0, 0
    v_pk_mov_b32 v[144:145], 0, 0
    v_pk_mov_b32 v[146:147], 0, 0
    v_pk_mov_b32 v[148:149], 0, 0
    v_pk_mov_b32 v[150:151], 0, 0
    v_pk_mov_b32 v[152:153], 0, 0
    v_pk_mov_b32 v[154:155], 0, 0
    v_pk_mov_b32 v[156:157], 0, 0
    v_pk_mov_b32 v[158:159], 0, 0
    v_pk_mov_b32 v[160:161], 0, 0
    v_pk_mov_b32 v[162:163], 0, 0
    v_pk_mov_b32 v[164:165], 0, 0
    v_pk_mov_b32 v[166:167], 0, 0
    s_load_dwordx2 s[36:37], s[0:1], 56
    s_mov_b32 s38, 0x80000
    s_mov_b32 s39, 0x20000
    s_lshl_b32 s54, s44, 8
    v_and_b32 v47, 15, v1
    v_lshlrev_b32 v47, 4, v47
    v_lshrrev_b32 v7, 4, v1
    v_lshl_add_u32 v47, v7, 13, v47
    s_mov_b32 s10, 0x05040100
    s_mov_b32 s11, 0x07060302
    s_waitcnt lgkmcnt(0)
    s_barrier
    s_barrier
    s_branch SLOWS3
SLOWS2:
    s_bitcmp1_b32 s53, s49
    s_cbranch_scc0 SLOWS3
    v_smfmac_f32_16x16x64_bf16 v[136:139], v[24:27], v[72:79], v2
    v_smfmac_f32_16x16x64_bf16 v[140:143], v[24:27], v[80:87], v2
    v_smfmac_f32_16x16x64_bf16 v[144:147], v[24:27], v[88:95], v2
    v_smfmac_f32_16x16x64_bf16 v[148:151], v[24:27], v[96:103], v2
    v_smfmac_f32_16x16x64_bf16 v[152:155], v[24:27], v[104:111], v2
    v_smfmac_f32_16x16x64_bf16 v[156:159], v[24:27], v[112:119], v2
    v_smfmac_f32_16x16x64_bf16 v[160:163], v[24:27], v[120:127], v2
    v_smfmac_f32_16x16x64_bf16 v[164:167], v[24:27], v[128:135], v2
SLOWS3:
    s_add_u32 s49, s49, 1
    s_cmp_eq_u32 s49, 8
    s_cbranch_scc1 SLOWF
    s_add_u32 s3, s54, 4096
    buffer_load_dwordx4 v[8:11], v47, s[36:39], s54 offen offset:0
    buffer_load_dwordx4 v[12:15], v47, s[36:39], s54 offen offset:1024
    buffer_load_dwordx4 v[16:19], v47, s[36:39], s3 offen offset:0
    buffer_load_dwordx4 v[20:23], v47, s[36:39], s3 offen offset:1024
    buffer_load_dwordx4 v[24:27], v47, s[36:39], s54 offen offset:2048
    buffer_load_dwordx4 v[28:31], v47, s[36:39], s54 offen offset:3072
    buffer_load_dwordx4 v[32:35], v47, s[36:39], s3 offen offset:2048
    buffer_load_dwordx4 v[36:39], v47, s[36:39], s3 offen offset:3072
    s_add_u32 s54, s54, 0x8000
    s_waitcnt vmcnt(0)
    v_perm_b32 v72, v12, v8, s10
    v_perm_b32 v73, v20, v16, s10
    v_perm_b32 v74, v28, v24, s10
    v_perm_b32 v75, v36, v32, s10
    v_perm_b32 v80, v12, v8, s11
    v_perm_b32 v81, v20, v16, s11
    v_perm_b32 v82, v28, v24, s11
    v_perm_b32 v83, v36, v32, s11
    v_perm_b32 v88, v13, v9, s10
    v_perm_b32 v89, v21, v17, s10
    v_perm_b32 v90, v29, v25, s10
    v_perm_b32 v91, v37, v33, s10
    v_perm_b32 v96, v13, v9, s11
    v_perm_b32 v97, v21, v17, s11
    v_perm_b32 v98, v29, v25, s11
    v_perm_b32 v99, v37, v33, s11
    v_perm_b32 v104, v14, v10, s10
    v_perm_b32 v105, v22, v18, s10
    v_perm_b32 v106, v30, v26, s10
    v_perm_b32 v107, v38, v34, s10
    v_perm_b32 v112, v14, v10, s11
    v_perm_b32 v113, v22, v18, s11
    v_perm_b32 v114, v30, v26, s11
    v_perm_b32 v115, v38, v34, s11
    v_perm_b32 v120, v15, v11, s10
    v_perm_b32 v121, v23, v19, s10
    v_perm_b32 v122, v31, v27, s10
    v_perm_b32 v123, v39, v35, s10
    v_perm_b32 v128, v15, v11, s11
    v_perm_b32 v129, v23, v19, s11
    v_perm_b32 v130, v31, v27, s11
    v_perm_b32 v131, v39, v35, s11
    s_add_u32 s3, s54, 4096
    buffer_load_dwordx4 v[8:11], v47, s[36:39], s54 offen offset:0
    buffer_load_dwordx4 v[12:15], v47, s[36:39], s54 offen offset:1024
    buffer_load_dwordx4 v[16:19], v47, s[36:39], s3 offen offset:0
    buffer_load_dwordx4 v[20:23], v47, s[36:39], s3 offen offset:1024
    buffer_load_dwordx4 v[24:27], v47, s[36:39], s54 offen offset:2048
    buffer_load_dwordx4 v[28:31], v47, s[36:39], s54 offen offset:3072
    buffer_load_dwordx4 v[32:35], v47, s[36:39], s3 offen offset:2048
    buffer_load_dwordx4 v[36:39], v47, s[36:39], s3 offen offset:3072
    s_add_u32 s54, s54, 0x8000
    s_waitcnt vmcnt(0)
    v_perm_b32 v76, v12, v8, s10
    v_perm_b32 v77, v20, v16, s10
    v_perm_b32 v78, v28, v24, s10
    v_perm_b32 v79, v36, v32, s10
    v_perm_b32 v84, v12, v8, s11
    v_perm_b32 v85, v20, v16, s11
    v_perm_b32 v86, v28, v24, s11
    v_perm_b32 v87, v36, v32, s11
    v_perm_b32 v92, v13, v9, s10
    v_perm_b32 v93, v21, v17, s10
    v_perm_b32 v94, v29, v25, s10
    v_perm_b32 v95, v37, v33, s10
    v_perm_b32 v100, v13, v9, s11
    v_perm_b32 v101, v21, v17, s11
    v_perm_b32 v102, v29, v25, s11
    v_perm_b32 v103, v37, v33, s11
    v_perm_b32 v108, v14, v10, s10
    v_perm_b32 v109, v22, v18, s10
    v_perm_b32 v110, v30, v26, s10
    v_perm_b32 v111, v38, v34, s10
    v_perm_b32 v116, v14, v10, s11
    v_perm_b32 v117, v22, v18, s11
    v_perm_b32 v118, v30, v26, s11
    v_perm_b32 v119, v38, v34, s11
    v_perm_b32 v124, v15, v11, s10
    v_perm_b32 v125, v23, v19, s10
    v_perm_b32 v126, v31, v27, s10
    v_perm_b32 v127, v39, v35, s10
    v_perm_b32 v132, v15, v11, s11
    v_perm_b32 v133, v23, v19, s11
    v_perm_b32 v134, v31, v27, s11
    v_perm_b32 v135, v39, v35, s11
    s_branch LAST
SLOWF:
    v_and_b32 v63, 15, v1
    v_lshlrev_b32 v63, 9, v63
    v_bfe_u32 v7, v1, 4, 1
    v_lshl_add_u32 v63, v7, 6, v63
    v_lshrrev_b32 v7, 5, v1
    v_lshl_add_u32 v63, v7, 5, v63
    buffer_load_dwordx4 v[64:67], v63, s[28:31], s15 offen offset:0 sc1
    buffer_load_dwordx4 v[68:71], v63, s[28:31], s15 offen offset:16 sc1
    v_and_b32 v6, 15, v1
    v_lshlrev_b32 v6, 4, v6
    v_bfe_u32 v7, v1, 4, 1
    v_lshl_add_u32 v6, v7, 12, v6
    v_lshrrev_b32 v7, 5, v1
    v_lshl_add_u32 v1, v7, 11, v6
    s_waitcnt vmcnt(0)
    v_lshlrev_b32 v40, 16, v64
    v_and_b32 v42, 0xffff0000, v64
    v_lshlrev_b32 v41, 16, v68
    v_and_b32 v43, 0xffff0000, v68
    v_lshlrev_b32 v44, 16, v65
    v_and_b32 v62, 0xffff0000, v65
    v_lshlrev_b32 v45, 16, v69
    v_and_b32 v63, 0xffff0000, v69
    v_lshlrev_b32 v64, 16, v66
    v_and_b32 v68, 0xffff0000, v66
    v_lshlrev_b32 v65, 16, v70
    v_and_b32 v69, 0xffff0000, v70
    v_lshlrev_b32 v66, 16, v67
    v_and_b32 v70, 0xffff0000, v67
    v_lshlrev_b32 v67, 16, v71
    v_and_b32 v71, 0xffff0000, v71
    v_permlane32_swap_b32 v136, v138
    v_permlane32_swap_b32 v137, v139
    v_pk_add_f32 v[136:137], v[136:137], v[138:139]
    v_pk_add_f32 v[136:137], v[136:137], v[40:41]
    v_permlane32_swap_b32 v140, v142
    v_permlane32_swap_b32 v141, v143
    v_pk_add_f32 v[140:141], v[140:141], v[142:143]
    v_pk_add_f32 v[140:141], v[140:141], v[42:43]
    v_permlane32_swap_b32 v144, v146
    v_permlane32_swap_b32 v145, v147
    v_pk_add_f32 v[144:145], v[144:145], v[146:147]
    v_pk_add_f32 v[144:145], v[144:145], v[44:45]
    v_permlane32_swap_b32 v148, v150
    v_permlane32_swap_b32 v149, v151
    v_pk_add_f32 v[148:149], v[148:149], v[150:151]
    v_pk_add_f32 v[148:149], v[148:149], v[62:63]
    v_permlane32_swap_b32 v152, v154
    v_permlane32_swap_b32 v153, v155
    v_pk_add_f32 v[152:153], v[152:153], v[154:155]
    v_pk_add_f32 v[152:153], v[152:153], v[64:65]
    v_permlane32_swap_b32 v156, v158
    v_permlane32_swap_b32 v157, v159
    v_pk_add_f32 v[156:157], v[156:157], v[158:159]
    v_pk_add_f32 v[156:157], v[156:157], v[68:69]
    v_permlane32_swap_b32 v160, v162
    v_permlane32_swap_b32 v161, v163
    v_pk_add_f32 v[160:161], v[160:161], v[162:163]
    v_pk_add_f32 v[160:161], v[160:161], v[66:67]
    v_permlane32_swap_b32 v164, v166
    v_permlane32_swap_b32 v165, v167
    v_pk_add_f32 v[164:165], v[164:165], v[166:167]
    v_pk_add_f32 v[164:165], v[164:165], v[70:71]
    v_cvt_pk_bf16_f32 v8, v136, v140
    v_cvt_pk_bf16_f32 v9, v144, v148
    v_cvt_pk_bf16_f32 v10, v152, v156
    v_cvt_pk_bf16_f32 v11, v160, v164
    buffer_store_dwordx4 v[8:11], v1, s[32:35], s65 offen offset:0 sc1
    v_cvt_pk_bf16_f32 v12, v137, v141
    v_cvt_pk_bf16_f32 v13, v145, v149
    v_cvt_pk_bf16_f32 v14, v153, v157
    v_cvt_pk_bf16_f32 v15, v161, v165
    buffer_store_dwordx4 v[12:15], v1, s[32:35], s65 offen offset:1024 sc1
    s_endpgm
SLOWA:
    v_lshrrev_b32 v123, 2, v3
    v_bfe_u32 v120, v123, 3, 2
    v_lshlrev_b32 v120, 10, v120
    v_and_b32 v124, 0x27, v123
    v_lshl_add_u32 v120, v124, 4, v120
    v_and_b32 v121, 0x7c, v3
    s_mov_b32 s10, s52
    s_mov_b32 s49, 0
    s_barrier
SLOWM:
    buffer_load_dwordx4 v[4:7], v120, s[28:31], s10 offen sc1
    v_mov_b32 v122, 0xff800000
    s_waitcnt vmcnt(0)
    v_mfma_f32_32x32x16_bf16 v[104:119], v[8:11], v[4:7], 0
    s_nop 11
    v_max3_f32 v122, v122, v104, v105
    v_max3_f32 v122, v122, v106, v107
    v_max3_f32 v122, v122, v108, v109
    v_max3_f32 v122, v122, v110, v111
    v_max3_f32 v122, v122, v112, v113
    v_max3_f32 v122, v122, v114, v115
    v_max3_f32 v122, v122, v116, v117
    v_max3_f32 v122, v122, v118, v119
    v_mfma_f32_32x32x16_bf16 v[104:119], v[12:15], v[4:7], 0
    s_nop 11
    v_max3_f32 v122, v122, v104, v105
    v_max3_f32 v122, v122, v106, v107
    v_max3_f32 v122, v122, v108, v109
    v_max3_f32 v122, v122, v110, v111
    v_max3_f32 v122, v122, v112, v113
    v_max3_f32 v122, v122, v114, v115
    v_max3_f32 v122, v122, v116, v117
    v_max3_f32 v122, v122, v118, v119
    v_mfma_f32_32x32x16_bf16 v[104:119], v[16:19], v[4:7], 0
    s_nop 11
    v_max3_f32 v122, v122, v104, v105
    v_max3_f32 v122, v122, v106, v107
    v_max3_f32 v122, v122, v108, v109
    v_max3_f32 v122, v122, v110, v111
    v_max3_f32 v122, v122, v112, v113
    v_max3_f32 v122, v122, v114, v115
    v_max3_f32 v122, v122, v116, v117
    v_max3_f32 v122, v122, v118, v119
    v_mfma_f32_32x32x16_bf16 v[104:119], v[20:23], v[4:7], 0
    s_nop 11
    v_max3_f32 v122, v122, v104, v105
    v_max3_f32 v122, v122, v106, v107
    v_max3_f32 v122, v122, v108, v109
    v_max3_f32 v122, v122, v110, v111
    v_max3_f32 v122, v122, v112, v113
    v_max3_f32 v122, v122, v114, v115
    v_max3_f32 v122, v122, v116, v117
    v_max3_f32 v122, v122, v118, v119
    v_mfma_f32_32x32x16_bf16 v[104:119], v[24:27], v[4:7], 0
    s_nop 11
    v_max3_f32 v122, v122, v104, v105
    v_max3_f32 v122, v122, v106, v107
    v_max3_f32 v122, v122, v108, v109
    v_max3_f32 v122, v122, v110, v111
    v_max3_f32 v122, v122, v112, v113
    v_max3_f32 v122, v122, v114, v115
    v_max3_f32 v122, v122, v116, v117
    v_max3_f32 v122, v122, v118, v119
    v_mfma_f32_32x32x16_bf16 v[104:119], v[28:31], v[4:7], 0
    s_nop 11
    v_max3_f32 v122, v122, v104, v105
    v_max3_f32 v122, v122, v106, v107
    v_max3_f32 v122, v122, v108, v109
    v_max3_f32 v122, v122, v110, v111
    v_max3_f32 v122, v122, v112, v113
    v_max3_f32 v122, v122, v114, v115
    v_max3_f32 v122, v122, v116, v117
    v_max3_f32 v122, v122, v118, v119
    v_mfma_f32_32x32x16_bf16 v[104:119], v[32:35], v[4:7], 0
    s_nop 11
    v_max3_f32 v122, v122, v104, v105
    v_max3_f32 v122, v122, v106, v107
    v_max3_f32 v122, v122, v108, v109
    v_max3_f32 v122, v122, v110, v111
    v_max3_f32 v122, v122, v112, v113
    v_max3_f32 v122, v122, v114, v115
    v_max3_f32 v122, v122, v116, v117
    v_max3_f32 v122, v122, v118, v119
    v_mfma_f32_32x32x16_bf16 v[104:119], v[36:39], v[4:7], 0
    s_nop 11
    v_max3_f32 v122, v122, v104, v105
    v_max3_f32 v122, v122, v106, v107
    v_max3_f32 v122, v122, v108, v109
    v_max3_f32 v122, v122, v110, v111
    v_max3_f32 v122, v122, v112, v113
    v_max3_f32 v122, v122, v114, v115
    v_max3_f32 v122, v122, v116, v117
    v_max3_f32 v122, v122, v118, v119
    ds_max_f32 v121, v122 offset:21504
    v_add_u32 v121, 128, v121
    s_add_u32 s10, s10, 4096
    s_add_u32 s49, s49, 1
    s_cmp_lt_u32 s49, 8
    s_cbranch_scc1 SLOWM
    v_and_b32 v121, 0x7c, v3
    s_mov_b32 s10, s52
    s_mov_b32 s49, 0
    s_waitcnt lgkmcnt(0)
    s_barrier
SLOWP:
    buffer_load_dwordx4 v[4:7], v120, s[28:31], s10 offen sc1
    ds_read_b32 v122, v121 offset:21504
    v_mov_b32 v136, 0
    v_mov_b32 v137, 0
    v_mov_b32 v138, 0
    v_mov_b32 v139, 0
    v_mov_b32 v140, 0
    v_mov_b32 v141, 0
    v_mov_b32 v142, 0
    v_mov_b32 v143, 0
    v_mov_b32 v144, 0
    s_waitcnt vmcnt(0) lgkmcnt(0)
    v_sub_f32 v152, 0, v122
    v_sub_f32 v153, 0, v122
    v_sub_f32 v154, 0, v122
    v_sub_f32 v155, 0, v122
    v_sub_f32 v156, 0, v122
    v_sub_f32 v157, 0, v122
    v_sub_f32 v158, 0, v122
    v_sub_f32 v159, 0, v122
    v_sub_f32 v160, 0, v122
    v_sub_f32 v161, 0, v122
    v_sub_f32 v162, 0, v122
    v_sub_f32 v163, 0, v122
    v_sub_f32 v164, 0, v122
    v_sub_f32 v165, 0, v122
    v_sub_f32 v166, 0, v122
    v_sub_f32 v167, 0, v122
    s_nop 1
    v_mfma_f32_32x32x16_bf16 v[104:119], v[8:11], v[4:7], v[152:167]
    s_nop 11
    v_exp_f32 v104, v104
    v_exp_f32 v105, v105
    v_exp_f32 v106, v106
    v_exp_f32 v107, v107
    v_exp_f32 v108, v108
    v_exp_f32 v109, v109
    v_exp_f32 v110, v110
    v_exp_f32 v111, v111
    v_exp_f32 v112, v112
    v_exp_f32 v113, v113
    v_exp_f32 v114, v114
    v_exp_f32 v115, v115
    v_exp_f32 v116, v116
    v_exp_f32 v117, v117
    v_exp_f32 v118, v118
    v_exp_f32 v119, v119
    v_smfmac_f32_32x32x32_bf16 v[136:151], v[40:43], v[104:111], v2
    s_nop 0
    v_smfmac_f32_32x32x32_bf16 v[136:151], v[44:47], v[112:119], v2
    v_mfma_f32_32x32x16_bf16 v[104:119], v[12:15], v[4:7], v[152:167]
    s_nop 11
    v_exp_f32 v104, v104
    v_exp_f32 v105, v105
    v_exp_f32 v106, v106
    v_exp_f32 v107, v107
    v_exp_f32 v108, v108
    v_exp_f32 v109, v109
    v_exp_f32 v110, v110
    v_exp_f32 v111, v111
    v_exp_f32 v112, v112
    v_exp_f32 v113, v113
    v_exp_f32 v114, v114
    v_exp_f32 v115, v115
    v_exp_f32 v116, v116
    v_exp_f32 v117, v117
    v_exp_f32 v118, v118
    v_exp_f32 v119, v119
    v_smfmac_f32_32x32x32_bf16 v[136:151], v[48:51], v[104:111], v2
    s_nop 0
    v_smfmac_f32_32x32x32_bf16 v[136:151], v[52:55], v[112:119], v2
    v_mfma_f32_32x32x16_bf16 v[104:119], v[16:19], v[4:7], v[152:167]
    s_nop 11
    v_exp_f32 v104, v104
    v_exp_f32 v105, v105
    v_exp_f32 v106, v106
    v_exp_f32 v107, v107
    v_exp_f32 v108, v108
    v_exp_f32 v109, v109
    v_exp_f32 v110, v110
    v_exp_f32 v111, v111
    v_exp_f32 v112, v112
    v_exp_f32 v113, v113
    v_exp_f32 v114, v114
    v_exp_f32 v115, v115
    v_exp_f32 v116, v116
    v_exp_f32 v117, v117
    v_exp_f32 v118, v118
    v_exp_f32 v119, v119
    v_smfmac_f32_32x32x32_bf16 v[136:151], v[56:59], v[104:111], v2
    s_nop 0
    v_smfmac_f32_32x32x32_bf16 v[136:151], v[60:63], v[112:119], v2
    v_mfma_f32_32x32x16_bf16 v[104:119], v[20:23], v[4:7], v[152:167]
    s_nop 11
    v_exp_f32 v104, v104
    v_exp_f32 v105, v105
    v_exp_f32 v106, v106
    v_exp_f32 v107, v107
    v_exp_f32 v108, v108
    v_exp_f32 v109, v109
    v_exp_f32 v110, v110
    v_exp_f32 v111, v111
    v_exp_f32 v112, v112
    v_exp_f32 v113, v113
    v_exp_f32 v114, v114
    v_exp_f32 v115, v115
    v_exp_f32 v116, v116
    v_exp_f32 v117, v117
    v_exp_f32 v118, v118
    v_exp_f32 v119, v119
    v_smfmac_f32_32x32x32_bf16 v[136:151], v[64:67], v[104:111], v2
    s_nop 0
    v_smfmac_f32_32x32x32_bf16 v[136:151], v[68:71], v[112:119], v2
    v_mfma_f32_32x32x16_bf16 v[104:119], v[24:27], v[4:7], v[152:167]
    s_nop 11
    v_exp_f32 v104, v104
    v_exp_f32 v105, v105
    v_exp_f32 v106, v106
    v_exp_f32 v107, v107
    v_exp_f32 v108, v108
    v_exp_f32 v109, v109
    v_exp_f32 v110, v110
    v_exp_f32 v111, v111
    v_exp_f32 v112, v112
    v_exp_f32 v113, v113
    v_exp_f32 v114, v114
    v_exp_f32 v115, v115
    v_exp_f32 v116, v116
    v_exp_f32 v117, v117
    v_exp_f32 v118, v118
    v_exp_f32 v119, v119
    v_smfmac_f32_32x32x32_bf16 v[136:151], v[72:75], v[104:111], v2
    s_nop 0
    v_smfmac_f32_32x32x32_bf16 v[136:151], v[76:79], v[112:119], v2
    v_mfma_f32_32x32x16_bf16 v[104:119], v[28:31], v[4:7], v[152:167]
    s_nop 11
    v_exp_f32 v104, v104
    v_exp_f32 v105, v105
    v_exp_f32 v106, v106
    v_exp_f32 v107, v107
    v_exp_f32 v108, v108
    v_exp_f32 v109, v109
    v_exp_f32 v110, v110
    v_exp_f32 v111, v111
    v_exp_f32 v112, v112
    v_exp_f32 v113, v113
    v_exp_f32 v114, v114
    v_exp_f32 v115, v115
    v_exp_f32 v116, v116
    v_exp_f32 v117, v117
    v_exp_f32 v118, v118
    v_exp_f32 v119, v119
    v_smfmac_f32_32x32x32_bf16 v[136:151], v[80:83], v[104:111], v2
    s_nop 0
    v_smfmac_f32_32x32x32_bf16 v[136:151], v[84:87], v[112:119], v2
    v_mfma_f32_32x32x16_bf16 v[104:119], v[32:35], v[4:7], v[152:167]
    s_nop 11
    v_exp_f32 v104, v104
    v_exp_f32 v105, v105
    v_exp_f32 v106, v106
    v_exp_f32 v107, v107
    v_exp_f32 v108, v108
    v_exp_f32 v109, v109
    v_exp_f32 v110, v110
    v_exp_f32 v111, v111
    v_exp_f32 v112, v112
    v_exp_f32 v113, v113
    v_exp_f32 v114, v114
    v_exp_f32 v115, v115
    v_exp_f32 v116, v116
    v_exp_f32 v117, v117
    v_exp_f32 v118, v118
    v_exp_f32 v119, v119
    v_smfmac_f32_32x32x32_bf16 v[136:151], v[88:91], v[104:111], v2
    s_nop 0
    v_smfmac_f32_32x32x32_bf16 v[136:151], v[92:95], v[112:119], v2
    v_mfma_f32_32x32x16_bf16 v[104:119], v[36:39], v[4:7], v[152:167]
    s_nop 11
    v_exp_f32 v104, v104
    v_exp_f32 v105, v105
    v_exp_f32 v106, v106
    v_exp_f32 v107, v107
    v_exp_f32 v108, v108
    v_exp_f32 v109, v109
    v_exp_f32 v110, v110
    v_exp_f32 v111, v111
    v_exp_f32 v112, v112
    v_exp_f32 v113, v113
    v_exp_f32 v114, v114
    v_exp_f32 v115, v115
    v_exp_f32 v116, v116
    v_exp_f32 v117, v117
    v_exp_f32 v118, v118
    v_exp_f32 v119, v119
    v_smfmac_f32_32x32x32_bf16 v[136:151], v[96:99], v[104:111], v2
    s_nop 0
    v_smfmac_f32_32x32x32_bf16 v[136:151], v[100:103], v[112:119], v2
    s_nop 11
    ds_write_b128 v1, v[136:139] offset:49152
    ds_write_b128 v1, v[140:143] offset:50176
    ds_write_addtid_b32 v144 offset:6144
    v_add_u32 v121, 128, v121
    s_add_u32 s10, s10, 4096
    s_add_u32 s49, s49, 1
    s_waitcnt lgkmcnt(0)
    s_barrier
    s_barrier
    s_cmp_lt_u32 s49, 8
    s_cbranch_scc1 SLOWP
END:
    s_endpgm

.p2align 8
.fill 4096, 4, 0xbf810000
.section .rodata,"a"
.p2align 6
.amdhsa_kernel gated_mix__linear_attn_block__grouped_kv_mqa__prompt_kernel
  .amdhsa_next_free_vgpr 168
  .amdhsa_next_free_sgpr 100
  .amdhsa_accum_offset 168
  .amdhsa_group_segment_fixed_size 0
  .amdhsa_kernarg_size 96
  .amdhsa_user_sgpr_count 2
  .amdhsa_user_sgpr_kernarg_segment_ptr 1
  .amdhsa_system_sgpr_workgroup_id_x 1
.end_amdhsa_kernel
```
